```python
import torch

def _softmax(x, axis=-1):
    return torch.softmax(x, dim=axis)
def _gelu(x):
    return torch.nn.functional.gelu(x, approximate="tanh")
def _silu(x):
    return torch.nn.functional.silu(x)
def _sigmoid(x):
    return torch.sigmoid(x)
def _layernorm(x, axis=-1, eps=1e-5):
    m = x.mean(dim=axis, keepdim=True)
    v = x.var(dim=axis, keepdim=True, unbiased=False)
    return (x - m) / torch.sqrt(v + eps)
def _scatter_add(tgt, idx, src, axis=0):
    return tgt.clone().index_add_(axis, idx, src)
def _segment_sum(src, seg, n):
    out = torch.zeros((n,) + src.shape[1:], dtype=src.dtype)
    return out.index_add_(0, seg, src)
def _pad(x, pw):
    flat = tuple(v for pair in reversed(pw) for v in pair)
    return torch.nn.functional.pad(x, flat)

kernel_name = 'gated_mix__gqa_block_cached__sliding_block_cached__decode'

def setup_inputs():

    _w = (lambda a: (lambda t: t.to(torch.bfloat16) if t.is_floating_point() else t)(torch.as_tensor(a)))
    def _A_setup():
        B, Sq, D = 2, 1, 512
        Hq, Hkv, Sk, Dh = 32, 32, 4096, 128
        assert Hq % Hkv == 0, (Hq, Hkv)
        return {
            "x": _w((lambda *s: torch.randn(*s, dtype=torch.bfloat16) * 0.05)(B, Sq, D)),
            "k_cache": _w((lambda *s: torch.randn(*s, dtype=torch.bfloat16) * 6.4)(B, Hkv, Sk, Dh)),
            "v_cache": _w((lambda *s: torch.randn(*s, dtype=torch.bfloat16) * 0.05)(B, Hkv, Sk, Dh)),
            "wq": _w((lambda *s: torch.randn(*s, dtype=torch.bfloat16) * 6.4)(D, Hq * Dh) * (D ** -0.5)),
            "wo": _w((lambda *s: torch.randn(*s, dtype=torch.bfloat16) * 0.05)(Hq * Dh, D) * ((Hq * Dh) ** -0.5)),
        }
    _A_in = _A_setup()

    def _B_setup():
        B, Sq, D = 2, 1, 512
        Hq, Hkv, Sk, Dh = 32, 32, 4096, 128
        assert Hq % Hkv == 0, (Hq, Hkv)
        return {
            "x": _w((lambda *s: torch.randn(*s, dtype=torch.bfloat16) * 0.05)(B, Sq, D)),
            "k_cache": _w((lambda *s: torch.randn(*s, dtype=torch.bfloat16) * 6.4)(B, Hkv, Sk, Dh)),
            "v_cache": _w((lambda *s: torch.randn(*s, dtype=torch.bfloat16) * 0.05)(B, Hkv, Sk, Dh)),
            "wq": _w((lambda *s: torch.randn(*s, dtype=torch.bfloat16) * 6.4)(D, Hq * Dh) * (D ** -0.5)),
            "wo": _w((lambda *s: torch.randn(*s, dtype=torch.bfloat16) * 0.05)(Hq * Dh, D) * ((Hq * Dh) ** -0.5)),
        }
    _B_in = _B_setup()

    return {
        "A_x": _A_in["x"],
        "A_k_cache": _A_in["k_cache"],
        "A_v_cache": _A_in["v_cache"],
        "A_wq": _A_in["wq"],
        "A_wo": _A_in["wo"],
        "B_x": _B_in["x"],
        "B_k_cache": _B_in["k_cache"],
        "B_v_cache": _B_in["v_cache"],
        "B_wq": _B_in["wq"],
        "B_wo": _B_in["wo"],
        "gate_w": _w((lambda *s: torch.randn(*s, dtype=torch.bfloat16) * 0.05)(512) * 16.0),
    }

def reference(A_x, A_k_cache, A_v_cache, A_wq, A_wo, B_x, B_k_cache, B_v_cache, B_wq, B_wo, gate_w):
    def _A_ref(x, k_cache, v_cache, wq, wo):
        B, Sq, D = x.shape
        Hq, Dh = 32, 128
        Hkv = k_cache.shape[1]
        rep = Hq // Hkv
        q = (lambda x, *d: x.permute(*d))((x @ wq).reshape(B, Sq, Hq, Dh), 0, 2, 1, 3)
        k = (lambda x, n, axis: torch.repeat_interleave(x, n, dim=axis))(k_cache, rep, axis=1)
        v = (lambda x, n, axis: torch.repeat_interleave(x, n, dim=axis))(v_cache, rep, axis=1)
        scores = torch.einsum("bhqd,bhkd->bhqk", q, k) * (Dh ** -0.5)
        p = _softmax(scores, axis=-1)
        o = torch.einsum("bhqk,bhkd->bhqd", p, v)
        return (lambda x, *d: x.permute(*d))(o, 0, 2, 1, 3).reshape(B, Sq, Hq * Dh) @ wo

    def _B_ref(x, k_cache, v_cache, wq, wo):
        B, Sq, D = x.shape
        Hq, Dh = 32, 128
        Hkv, Sk = k_cache.shape[1], k_cache.shape[2]
        W = min(4096, max(256, Sk // 4))
        rep = Hq // Hkv
        q = (lambda x, *d: x.permute(*d))((x @ wq).reshape(B, Sq, Hq, Dh), 0, 2, 1, 3)
        k = (lambda x, n, axis: torch.repeat_interleave(x, n, dim=axis))(k_cache[:, :, Sk - W:, :], rep, axis=1)
        v = (lambda x, n, axis: torch.repeat_interleave(x, n, dim=axis))(v_cache[:, :, Sk - W:, :], rep, axis=1)
        scores = torch.einsum("bhqd,bhkd->bhqk", q, k) * (Dh ** -0.5)
        p = _softmax(scores, axis=-1)
        o = torch.einsum("bhqk,bhkd->bhqd", p, v)
        return (lambda x, *d: x.permute(*d))(o, 0, 2, 1, 3).reshape(B, Sq, Hq * Dh) @ wo

    x = A_x
    g = _sigmoid((x * gate_w).sum(-1, keepdims=True))
    a = _A_ref(x, A_k_cache, A_v_cache, A_wq, A_wo)
    b = _B_ref(x, B_k_cache, B_v_cache, B_wq, B_wo)
    return g * a + (1 - g) * b
```

```asm
; @launch grid=(256,1,1) block=(320,1,1) lds=162992
.amdgcn_target "amdgcn-amd-amdhsa--gfx950"
.text
.globl gated_mix__gqa_block_cached__sliding_block_cached__decode_kernel
.p2align 8
.type gated_mix__gqa_block_cached__sliding_block_cached__decode_kernel,@function
gated_mix__gqa_block_cached__sliding_block_cached__decode_kernel:
s_cmp_ge_u32 s2, 256
s_cbranch_scc1 L_end
s_load_dwordx16 s[4:19], s[0:1], 0
s_load_dwordx8 s[20:27], s[0:1], 64
s_load_dwordx4 s[28:31], s[0:1], 96
v_lshrrev_b32 v1, 6, v0
s_and_b32 s32, s2, 7
s_lshr_b32 s33, s2, 3
v_readfirstlane_b32 s38, v1
v_and_b32 v0, 63, v0
s_lshr_b32 s34, s33, 3
s_lshl2_add_u32 s34, s32, s34
s_and_b32 s35, s33, 7
s_lshr_b32 s36, s35, 2
s_and_b32 s37, s35, 3
v_lshrrev_b32 v16, 4, v0
v_and_b32 v17, 15, v0
s_cmp_lg_u32 s38, 0
s_cbranch_scc1 L_comp
s_getpc_b64 s[40:41]
L_pf:
s_lshl_b32 s42, s33, 10
s_min_u32 s42, s42, L_codeend-L_pf-1024
s_and_b32 s42, s42, -16
s_and_b32 s40, s40, -16
v_lshl_add_u32 v1, v0, 4, s42
global_load_dwordx4 v[48:51], v1, s[40:41]
s_setprio 3
s_and_b32 s53, s35, 1
s_lshr_b32 s43, s35, 1
v_lshlrev_b32 v1, 18, v16
v_lshl_add_u32 v1, v17, 4, v1
v_lshrrev_b32 v2, 3, v17
v_lshlrev_b32 v2, 10, v2
v_lshl_add_u32 v2, v16, 6, v2
s_lshl_b32 s40, s43, 8
v_add_u32 v2, s40, v2
s_lshl_b32 s40, s43, 20
s_lshl_b32 s41, s34, 8
s_add_u32 s40, s40, s41
s_mov_b32 s46, 0x100000
s_mov_b32 s47, 0x20000
s_mov_b32 s72, 0
s_movk_i32 s73, 0x2000
s_cmp_eq_u32 s53, 0
s_waitcnt lgkmcnt(0)
s_cselect_b32 s44, s10, s20
s_cselect_b32 s45, s11, s21
s_add_u32 s44, s44, s40
s_addc_u32 s45, s45, 0
buffer_load_dwordx4 v[128:131], v1, s[44:47], s72 offen nt
s_add_u32 s72, s72, s73
buffer_load_dwordx4 v[132:135], v1, s[44:47], s72 offen nt
s_add_u32 s72, s72, s73
buffer_load_dwordx4 v[136:139], v1, s[44:47], s72 offen nt
s_add_u32 s72, s72, s73
buffer_load_dwordx4 v[140:143], v1, s[44:47], s72 offen nt
s_add_u32 s72, s72, s73
buffer_load_dwordx4 v[144:147], v1, s[44:47], s72 offen nt
s_add_u32 s72, s72, s73
buffer_load_dwordx4 v[148:151], v1, s[44:47], s72 offen nt
s_add_u32 s72, s72, s73
buffer_load_dwordx4 v[152:155], v1, s[44:47], s72 offen nt
s_add_u32 s72, s72, s73
buffer_load_dwordx4 v[156:159], v1, s[44:47], s72 offen nt
s_add_u32 s72, s72, s73
global_load_dwordx4 v[20:23], v2, s[4:5] offset:0
global_load_dwordx4 v[24:27], v2, s[4:5] offset:16
global_load_dwordx4 v[28:31], v2, s[4:5] offset:32
global_load_dwordx4 v[32:35], v2, s[4:5] offset:48
s_load_dwordx2 s[92:93], s[30:31], 622592
buffer_load_dwordx4 v[160:163], v1, s[44:47], s72 offen nt
s_add_u32 s72, s72, s73
buffer_load_dwordx4 v[164:167], v1, s[44:47], s72 offen nt
s_add_u32 s72, s72, s73
buffer_load_dwordx4 v[168:171], v1, s[44:47], s72 offen nt
s_add_u32 s72, s72, s73
buffer_load_dwordx4 v[172:175], v1, s[44:47], s72 offen nt
s_add_u32 s72, s72, s73
buffer_load_dwordx4 v[176:179], v1, s[44:47], s72 offen nt
s_add_u32 s72, s72, s73
buffer_load_dwordx4 v[180:183], v1, s[44:47], s72 offen nt
s_add_u32 s72, s72, s73
buffer_load_dwordx4 v[184:187], v1, s[44:47], s72 offen nt
s_add_u32 s72, s72, s73
buffer_load_dwordx4 v[188:191], v1, s[44:47], s72 offen nt
s_add_u32 s72, s72, s73
buffer_load_dwordx4 v[192:195], v1, s[44:47], s72 offen nt
s_add_u32 s72, s72, s73
buffer_load_dwordx4 v[196:199], v1, s[44:47], s72 offen nt
s_add_u32 s72, s72, s73
buffer_load_dwordx4 v[200:203], v1, s[44:47], s72 offen nt
s_add_u32 s72, s72, s73
buffer_load_dwordx4 v[204:207], v1, s[44:47], s72 offen nt
s_add_u32 s72, s72, s73
buffer_load_dwordx4 v[208:211], v1, s[44:47], s72 offen nt
s_add_u32 s72, s72, s73
buffer_load_dwordx4 v[212:215], v1, s[44:47], s72 offen nt
s_add_u32 s72, s72, s73
buffer_load_dwordx4 v[216:219], v1, s[44:47], s72 offen nt
s_add_u32 s72, s72, s73
buffer_load_dwordx4 v[220:223], v1, s[44:47], s72 offen nt
s_add_u32 s72, s72, s73
buffer_load_dwordx4 v[224:227], v1, s[44:47], s72 offen nt
s_add_u32 s72, s72, s73
buffer_load_dwordx4 v[228:231], v1, s[44:47], s72 offen nt
s_add_u32 s72, s72, s73
buffer_load_dwordx4 v[232:235], v1, s[44:47], s72 offen nt
s_add_u32 s72, s72, s73
buffer_load_dwordx4 v[236:239], v1, s[44:47], s72 offen nt
s_add_u32 s72, s72, s73
buffer_load_dwordx4 v[240:243], v1, s[44:47], s72 offen nt
s_add_u32 s72, s72, s73
buffer_load_dwordx4 v[244:247], v1, s[44:47], s72 offen nt
s_add_u32 s72, s72, s73
buffer_load_dwordx4 v[248:251], v1, s[44:47], s72 offen nt
s_add_u32 s72, s72, s73
buffer_load_dwordx4 v[252:255], v1, s[44:47], s72 offen nt
v_lshlrev_b32 v60, 4, v0
v_and_b32 v8, 1, v17
v_lshlrev_b32 v8, 4, v8
v_bfe_u32 v9, v17, 1, 2
v_mov_b32 v15, 0x0c0c0c0c
v_mov_b32 v10, 0xd0c
v_lshlrev_b32 v10, v8, v10
v_xor_b32 v10, v10, v15
v_cmp_eq_u32 vcc, 0, v9
s_nop 1
v_cndmask_b32 v36, v15, v10, vcc
v_cmp_eq_u32 vcc, 1, v9
s_nop 1
v_cndmask_b32 v37, v15, v10, vcc
v_cmp_eq_u32 vcc, 2, v9
s_nop 1
v_cndmask_b32 v38, v15, v10, vcc
v_cmp_eq_u32 vcc, 3, v9
s_nop 1
v_cndmask_b32 v39, v15, v10, vcc
v_mov_b32 v10, 0xf0e
v_lshlrev_b32 v10, v8, v10
v_xor_b32 v10, v10, v15
v_cmp_eq_u32 vcc, 0, v9
s_nop 1
v_cndmask_b32 v40, v15, v10, vcc
v_cmp_eq_u32 vcc, 1, v9
s_nop 1
v_cndmask_b32 v41, v15, v10, vcc
v_cmp_eq_u32 vcc, 2, v9
s_nop 1
v_cndmask_b32 v42, v15, v10, vcc
v_cmp_eq_u32 vcc, 3, v9
s_nop 1
v_cndmask_b32 v43, v15, v10, vcc
s_lshl_b32 s40, s34, 13
s_lshl_b32 s41, s53, 12
s_add_u32 s41, s40, s41
s_lshl_b32 s42, s43, 10
s_add_u32 s41, s41, s42
v_add_u32 v62, s41, v60
s_lshl_b32 s42, s36, 9
s_add_u32 s40, s40, s42
v_lshrrev_b32 v5, 5, v0
v_lshlrev_b32 v3, 12, v5
v_and_b32 v4, 31, v0
v_lshl_add_u32 v3, v4, 4, v3
v_add_u32 v3, s40, v3
v_lshlrev_b32 v5, 8, v5
v_lshl_add_u32 v5, v17, 4, v5
v_and_b32 v6, 1, v16
v_lshl_add_u32 v5, v6, 3, v5
v_add_u32 v5, 137728, v5
s_waitcnt lgkmcnt(0)
s_mul_i32 s92, s92, 0x9e3779b1
s_add_u32 s92, s92, 0x7f4a7c15
s_mul_i32 s93, s93, 0x85ebca6d
s_add_u32 s93, s93, 0x2545f491
s_bfe_u32 s84, s92, 0xa0000
s_bfe_u32 s85, s92, 0xa0010
s_bfe_u32 s86, s93, 0xa0000
s_bfe_u32 s87, s93, 0xa0010
v_mov_b32 v8, s92
v_mov_b32 v9, s93
v_and_b32 v10, 2, v0
v_cmp_eq_u32 vcc, 0, v10
v_and_b32 v10, 1, v0
s_and_b32 s41, s92, 1
v_cndmask_b32 v8, v9, v8, vcc
v_lshlrev_b32 v10, 4, v10
v_lshrrev_b32 v8, v10, v8
v_bfe_u32 v12, v8, 1, 3
v_lshl_or_b32 v12, v12, 1, s41
v_bfe_u32 v13, v8, 5, 3
v_lshl_or_b32 v13, v13, 1, s41
v_bfe_u32 v14, v8, 9, 3
v_lshl_or_b32 v14, v14, 1, s41
v_bfe_u32 v15, v8, 13, 3
v_lshl_or_b32 v15, v15, 1, s41
v_lshlrev_b32 v6, 2, v0
v_add_u32 v6, 138240, v6
v_mov_b32 v7, 0
v_writelane_b32 v7, s84, 36
v_writelane_b32 v7, s85, 37
v_writelane_b32 v7, s86, 38
v_writelane_b32 v7, s87, 39
v_writelane_b32 v7, s92, 40
v_writelane_b32 v7, s93, 41
s_mov_b32 exec_hi, 0x3ff
ds_write_b32 v6, v7
s_mov_b64 exec, -1
s_waitcnt vmcnt(24)
v_perm_b32 v64, v20, v20, v36
v_perm_b32 v65, v20, v20, v37
v_perm_b32 v66, v20, v20, v38
v_perm_b32 v67, v20, v20, v39
v_perm_b32 v68, v20, v20, v40
v_perm_b32 v69, v20, v20, v41
v_perm_b32 v70, v20, v20, v42
v_perm_b32 v71, v20, v20, v43
v_perm_b32 v72, v21, v21, v36
v_perm_b32 v73, v21, v21, v37
v_perm_b32 v74, v21, v21, v38
v_perm_b32 v75, v21, v21, v39
v_perm_b32 v76, v21, v21, v40
v_perm_b32 v77, v21, v21, v41
v_perm_b32 v78, v21, v21, v42
v_perm_b32 v79, v21, v21, v43
v_perm_b32 v80, v22, v22, v36
v_perm_b32 v81, v22, v22, v37
v_perm_b32 v82, v22, v22, v38
v_perm_b32 v83, v22, v22, v39
v_perm_b32 v84, v22, v22, v40
v_perm_b32 v85, v22, v22, v41
v_perm_b32 v86, v22, v22, v42
v_perm_b32 v87, v22, v22, v43
v_perm_b32 v88, v23, v23, v36
v_perm_b32 v89, v23, v23, v37
v_perm_b32 v90, v23, v23, v38
v_perm_b32 v91, v23, v23, v39
v_perm_b32 v92, v23, v23, v40
v_perm_b32 v93, v23, v23, v41
v_perm_b32 v94, v23, v23, v42
v_perm_b32 v95, v23, v23, v43
v_perm_b32 v96, v24, v24, v36
v_perm_b32 v97, v24, v24, v37
v_perm_b32 v98, v24, v24, v38
v_perm_b32 v99, v24, v24, v39
v_perm_b32 v100, v24, v24, v40
v_perm_b32 v101, v24, v24, v41
v_perm_b32 v102, v24, v24, v42
v_perm_b32 v103, v24, v24, v43
v_perm_b32 v104, v25, v25, v36
v_perm_b32 v105, v25, v25, v37
v_perm_b32 v106, v25, v25, v38
v_perm_b32 v107, v25, v25, v39
v_perm_b32 v108, v25, v25, v40
v_perm_b32 v109, v25, v25, v41
v_perm_b32 v110, v25, v25, v42
v_perm_b32 v111, v25, v25, v43
v_perm_b32 v112, v26, v26, v36
v_perm_b32 v113, v26, v26, v37
v_perm_b32 v114, v26, v26, v38
v_perm_b32 v115, v26, v26, v39
v_perm_b32 v116, v26, v26, v40
v_perm_b32 v117, v26, v26, v41
v_perm_b32 v118, v26, v26, v42
v_perm_b32 v119, v26, v26, v43
v_perm_b32 v120, v27, v27, v36
v_perm_b32 v121, v27, v27, v37
v_perm_b32 v122, v27, v27, v38
v_perm_b32 v123, v27, v27, v39
v_perm_b32 v124, v27, v27, v40
v_perm_b32 v125, v27, v27, v41
v_perm_b32 v126, v27, v27, v42
v_perm_b32 v127, v27, v27, v43
s_waitcnt vmcnt(31)
v_mfma_f32_16x16x32_bf16 v[52:55], v[64:67], v[128:131], 0
v_perm_b32 v64, v28, v28, v36
v_perm_b32 v65, v28, v28, v37
v_perm_b32 v66, v28, v28, v38
v_perm_b32 v67, v28, v28, v39
s_waitcnt vmcnt(30)
v_mfma_f32_16x16x32_bf16 v[52:55], v[68:71], v[132:135], v[52:55]
v_perm_b32 v68, v28, v28, v40
v_perm_b32 v69, v28, v28, v41
v_perm_b32 v70, v28, v28, v42
v_perm_b32 v71, v28, v28, v43
s_waitcnt vmcnt(29)
v_mfma_f32_16x16x32_bf16 v[52:55], v[72:75], v[136:139], v[52:55]
v_perm_b32 v72, v29, v29, v36
v_perm_b32 v73, v29, v29, v37
v_perm_b32 v74, v29, v29, v38
v_perm_b32 v75, v29, v29, v39
s_waitcnt vmcnt(28)
v_mfma_f32_16x16x32_bf16 v[52:55], v[76:79], v[140:143], v[52:55]
v_perm_b32 v76, v29, v29, v40
v_perm_b32 v77, v29, v29, v41
v_perm_b32 v78, v29, v29, v42
v_perm_b32 v79, v29, v29, v43
s_waitcnt vmcnt(27)
v_mfma_f32_16x16x32_bf16 v[52:55], v[80:83], v[144:147], v[52:55]
v_perm_b32 v80, v30, v30, v36
v_perm_b32 v81, v30, v30, v37
v_perm_b32 v82, v30, v30, v38
v_perm_b32 v83, v30, v30, v39
s_waitcnt vmcnt(26)
v_mfma_f32_16x16x32_bf16 v[52:55], v[84:87], v[148:151], v[52:55]
v_perm_b32 v84, v30, v30, v40
v_perm_b32 v85, v30, v30, v41
v_perm_b32 v86, v30, v30, v42
v_perm_b32 v87, v30, v30, v43
s_waitcnt vmcnt(25)
v_mfma_f32_16x16x32_bf16 v[52:55], v[88:91], v[152:155], v[52:55]
v_perm_b32 v88, v31, v31, v36
v_perm_b32 v89, v31, v31, v37
v_perm_b32 v90, v31, v31, v38
v_perm_b32 v91, v31, v31, v39
s_waitcnt vmcnt(24)
v_mfma_f32_16x16x32_bf16 v[52:55], v[92:95], v[156:159], v[52:55]
v_perm_b32 v92, v31, v31, v40
v_perm_b32 v93, v31, v31, v41
v_perm_b32 v94, v31, v31, v42
v_perm_b32 v95, v31, v31, v43
s_waitcnt vmcnt(23)
v_mfma_f32_16x16x32_bf16 v[52:55], v[96:99], v[160:163], v[52:55]
v_perm_b32 v96, v32, v32, v36
v_perm_b32 v97, v32, v32, v37
v_perm_b32 v98, v32, v32, v38
v_perm_b32 v99, v32, v32, v39
s_waitcnt vmcnt(22)
v_mfma_f32_16x16x32_bf16 v[52:55], v[100:103], v[164:167], v[52:55]
v_perm_b32 v100, v32, v32, v40
v_perm_b32 v101, v32, v32, v41
v_perm_b32 v102, v32, v32, v42
v_perm_b32 v103, v32, v32, v43
s_waitcnt vmcnt(21)
v_mfma_f32_16x16x32_bf16 v[52:55], v[104:107], v[168:171], v[52:55]
v_perm_b32 v104, v33, v33, v36
v_perm_b32 v105, v33, v33, v37
v_perm_b32 v106, v33, v33, v38
v_perm_b32 v107, v33, v33, v39
s_waitcnt vmcnt(20)
v_mfma_f32_16x16x32_bf16 v[52:55], v[108:111], v[172:175], v[52:55]
v_perm_b32 v108, v33, v33, v40
v_perm_b32 v109, v33, v33, v41
v_perm_b32 v110, v33, v33, v42
v_perm_b32 v111, v33, v33, v43
s_waitcnt vmcnt(19)
v_mfma_f32_16x16x32_bf16 v[52:55], v[112:115], v[176:179], v[52:55]
v_perm_b32 v112, v34, v34, v36
v_perm_b32 v113, v34, v34, v37
v_perm_b32 v114, v34, v34, v38
v_perm_b32 v115, v34, v34, v39
s_waitcnt vmcnt(18)
v_mfma_f32_16x16x32_bf16 v[52:55], v[116:119], v[180:183], v[52:55]
v_perm_b32 v116, v34, v34, v40
v_perm_b32 v117, v34, v34, v41
v_perm_b32 v118, v34, v34, v42
v_perm_b32 v119, v34, v34, v43
s_waitcnt vmcnt(17)
v_mfma_f32_16x16x32_bf16 v[52:55], v[120:123], v[184:187], v[52:55]
v_perm_b32 v120, v35, v35, v36
v_perm_b32 v121, v35, v35, v37
v_perm_b32 v122, v35, v35, v38
v_perm_b32 v123, v35, v35, v39
s_waitcnt vmcnt(16)
v_mfma_f32_16x16x32_bf16 v[52:55], v[124:127], v[188:191], v[52:55]
v_perm_b32 v124, v35, v35, v40
v_perm_b32 v125, v35, v35, v41
v_perm_b32 v126, v35, v35, v42
v_perm_b32 v127, v35, v35, v43
s_waitcnt vmcnt(15)
v_mfma_f32_16x16x32_bf16 v[52:55], v[64:67], v[192:195], v[52:55]
s_waitcnt vmcnt(14)
v_mfma_f32_16x16x32_bf16 v[52:55], v[68:71], v[196:199], v[52:55]
s_waitcnt vmcnt(13)
v_mfma_f32_16x16x32_bf16 v[52:55], v[72:75], v[200:203], v[52:55]
s_waitcnt vmcnt(12)
v_mfma_f32_16x16x32_bf16 v[52:55], v[76:79], v[204:207], v[52:55]
s_waitcnt vmcnt(11)
v_mfma_f32_16x16x32_bf16 v[52:55], v[80:83], v[208:211], v[52:55]
s_waitcnt vmcnt(10)
v_mfma_f32_16x16x32_bf16 v[52:55], v[84:87], v[212:215], v[52:55]
s_waitcnt vmcnt(9)
v_mfma_f32_16x16x32_bf16 v[52:55], v[88:91], v[216:219], v[52:55]
s_waitcnt vmcnt(8)
v_mfma_f32_16x16x32_bf16 v[52:55], v[92:95], v[220:223], v[52:55]
s_waitcnt vmcnt(7)
v_mfma_f32_16x16x32_bf16 v[52:55], v[96:99], v[224:227], v[52:55]
s_waitcnt vmcnt(6)
v_mfma_f32_16x16x32_bf16 v[52:55], v[100:103], v[228:231], v[52:55]
s_waitcnt vmcnt(5)
v_mfma_f32_16x16x32_bf16 v[52:55], v[104:107], v[232:235], v[52:55]
s_waitcnt vmcnt(4)
v_mfma_f32_16x16x32_bf16 v[52:55], v[108:111], v[236:239], v[52:55]
s_waitcnt vmcnt(3)
v_mfma_f32_16x16x32_bf16 v[52:55], v[112:115], v[240:243], v[52:55]
s_waitcnt vmcnt(2)
v_mfma_f32_16x16x32_bf16 v[52:55], v[116:119], v[244:247], v[52:55]
s_waitcnt vmcnt(1)
v_mfma_f32_16x16x32_bf16 v[52:55], v[120:123], v[248:251], v[52:55]
s_waitcnt vmcnt(0)
v_mfma_f32_16x16x32_bf16 v[52:55], v[124:127], v[252:255], v[52:55]
s_lshl_b32 s41, s36, 10
v_add_u32 v7, s41, v60
s_nop 5
v_bfi_b32 v8, 15, v12, v52
v_bfi_b32 v9, 15, v13, v53
v_bfi_b32 v10, 15, v14, v54
v_bfi_b32 v11, 15, v15, v55
global_store_dwordx4 v62, v[8:11], s[30:31] sc1
global_load_dwordx4 v[44:47], v7, s[4:5]
global_load_dwordx4 v[48:51], v60, s[24:25]
s_waitcnt vmcnt(0)
s_mov_b32 s67, 0xffff0000
v_lshlrev_b32 v52, 16, v44
v_and_b32 v53, s67, v44
v_lshlrev_b32 v54, 16, v48
v_and_b32 v55, s67, v48
v_mul_f32 v52, v52, v54
v_mul_f32 v53, v53, v55
v_cvt_pk_bf16_f32 v52, v52, v53
v_lshlrev_b32 v53, 16, v52
v_and_b32 v52, s67, v52
v_add_f32 v56, v52, v53
v_lshlrev_b32 v52, 16, v45
v_and_b32 v53, s67, v45
v_lshlrev_b32 v54, 16, v49
v_and_b32 v55, s67, v49
v_mul_f32 v52, v52, v54
v_mul_f32 v53, v53, v55
v_cvt_pk_bf16_f32 v52, v52, v53
v_lshlrev_b32 v53, 16, v52
v_and_b32 v52, s67, v52
v_add_f32 v56, v56, v52
v_add_f32 v56, v56, v53
v_lshlrev_b32 v52, 16, v46
v_and_b32 v53, s67, v46
v_lshlrev_b32 v54, 16, v50
v_and_b32 v55, s67, v50
v_mul_f32 v52, v52, v54
v_mul_f32 v53, v53, v55
v_cvt_pk_bf16_f32 v52, v52, v53
v_lshlrev_b32 v53, 16, v52
v_and_b32 v52, s67, v52
v_add_f32 v56, v56, v52
v_add_f32 v56, v56, v53
v_lshlrev_b32 v52, 16, v47
v_and_b32 v53, s67, v47
v_lshlrev_b32 v54, 16, v51
v_and_b32 v55, s67, v51
v_mul_f32 v52, v52, v54
v_mul_f32 v53, v53, v55
v_cvt_pk_bf16_f32 v52, v52, v53
v_lshlrev_b32 v53, 16, v52
v_and_b32 v52, s67, v52
v_add_f32 v56, v56, v52
v_add_f32 v56, v56, v53
s_nop 1
v_add_f32_dpp v56, v56, v56 row_ror:1 row_mask:0xf bank_mask:0xf
s_nop 1
v_add_f32_dpp v56, v56, v56 row_ror:2 row_mask:0xf bank_mask:0xf
s_nop 1
v_add_f32_dpp v56, v56, v56 row_ror:4 row_mask:0xf bank_mask:0xf
s_nop 1
v_add_f32_dpp v56, v56, v56 row_ror:8 row_mask:0xf bank_mask:0xf
s_nop 1
v_add_f32_dpp v56, v56, v56 row_bcast:15 row_mask:0xa bank_mask:0xf
s_nop 1
v_add_f32_dpp v56, v56, v56 row_bcast:31 row_mask:0xc bank_mask:0xf
v_cvt_pk_bf16_f32 v56, v56, v56
v_and_b32 v56, s67, v56
v_mul_f32 v56, 0xbfb8aa3b, v56
v_exp_f32 v56, v56
s_nop 0
v_add_f32 v56, 1.0, v56
v_rcp_f32 v56, v56
s_nop 0
v_cvt_pk_bf16_f32 v56, v56, v56
v_and_b32 v56, s67, v56
v_sub_f32 v57, 1.0, v56
v_cvt_pk_bf16_f32 v57, v57, v57
v_and_b32 v57, s67, v57
s_nop 1
v_readlane_b32 s54, v56, 63
v_readlane_b32 s55, v57, 63
s_lshl_b32 s52, s36, 5
s_add_u32 s52, s52, s34
s_lshl_b32 s52, s52, 9
s_add_u32 s52, s52, 524288
v_and_b32 v27, 3, v0
v_lshlrev_b32 v26, 7, v27
v_bfe_u32 v25, v0, 2, 1
v_lshl_add_u32 v26, v25, 4, v26
v_add_u32 v26, s52, v26
v_lshlrev_b32 v27, 2, v27
v_lshl_add_u32 v27, v25, 6, v27
v_add_u32 v27, 138240, v27
v_mov_b32 v28, 138240
v_lshl_add_u32 v29, v25, 2, v28
v_mov_b32 v30, s54
v_mov_b32 v31, s55
v_cmp_eq_u32 vcc, 1, v25
s_nop 1
v_cndmask_b32 v30, v30, v31, vcc
s_lshl_b32 s58, 0x11, s37
s_mov_b32 s59, 0
v_mov_b32 v33, s92
v_mov_b32 v35, s93
s_mov_b32 s90, 400000
L_qd:
global_load_dwordx4 v[64:67], v3, s[30:31] offset:0 sc1
global_load_dwordx4 v[68:71], v3, s[30:31] offset:1024 sc1
global_load_dwordx4 v[72:75], v3, s[30:31] offset:2048 sc1
global_load_dwordx4 v[76:79], v3, s[30:31] offset:3072 sc1
s_waitcnt vmcnt(0)
v_xor_b32 v64, v12, v64
v_xor_b32 v65, v13, v65
v_xor_b32 v66, v14, v66
v_xor_b32 v67, v15, v67
v_xor_b32 v68, v12, v68
v_xor_b32 v69, v13, v69
v_xor_b32 v70, v14, v70
v_xor_b32 v71, v15, v71
v_xor_b32 v72, v12, v72
v_xor_b32 v73, v13, v73
v_xor_b32 v74, v14, v74
v_xor_b32 v75, v15, v75
v_xor_b32 v76, v12, v76
v_xor_b32 v77, v13, v77
v_xor_b32 v78, v14, v78
v_xor_b32 v79, v15, v79
v_or3_b32 v8, v64, v65, v66
v_or3_b32 v8, v8, v67, v68
v_or3_b32 v8, v8, v69, v70
v_or3_b32 v8, v8, v71, v72
v_or3_b32 v8, v8, v73, v74
v_or3_b32 v8, v8, v75, v76
v_or3_b32 v8, v8, v77, v78
v_or_b32 v8, v8, v79
v_and_b32 v8, 15, v8
v_cmp_ne_u32 vcc, 0, v8
s_nop 1
s_cmp_eq_u64 vcc, 0
s_cbranch_scc1 L_qd_ok
s_sleep 4
s_sub_u32 s90, s90, 1
s_cbranch_scc0 L_qd
L_qd_ok:
v_pk_add_f32 v[64:65], v[64:65], v[68:69]
v_pk_add_f32 v[72:73], v[72:73], v[76:77]
v_pk_add_f32 v[66:67], v[66:67], v[70:71]
v_pk_add_f32 v[74:75], v[74:75], v[78:79]
v_pk_add_f32 v[8:9], v[64:65], v[72:73]
v_pk_add_f32 v[10:11], v[66:67], v[74:75]
v_cvt_pk_bf16_f32 v8, v8, v9
v_cvt_pk_bf16_f32 v9, v10, v11
ds_write_b64 v5, v[8:9]
s_waitcnt lgkmcnt(0)
s_barrier
s_setprio 0
s_barrier
s_mov_b32 s90, 1600000
L_wl:
s_sleep 8
ds_read_b32 v10, v27 offset:16
s_waitcnt lgkmcnt(0)
v_cmp_eq_u32 vcc, 0, v10
s_nop 1
s_cmp_eq_u64 vcc, 0
s_cbranch_scc1 L_wl_ok
s_sub_u32 s90, s90, 1
s_cbranch_scc0 L_wl
L_wl_ok:
ds_read_b32 v8, v27
s_waitcnt lgkmcnt(0)
v_mov_b32 v32, v8
s_nop 1
v_max_f32_dpp v32, v32, v32 quad_perm:[1,0,3,2] row_mask:0xf bank_mask:0xf
s_nop 1
v_max_f32_dpp v32, v32, v32 quad_perm:[2,3,0,1] row_mask:0xf bank_mask:0xf
v_sub_f32 v8, v8, v32
v_exp_f32 v8, v8
s_nop 0
v_mul_f32 v34, v10, v8
s_nop 1
v_add_f32_dpp v34, v34, v34 quad_perm:[1,0,3,2] row_mask:0xf bank_mask:0xf
s_nop 1
v_add_f32_dpp v34, v34, v34 quad_perm:[2,3,0,1] row_mask:0xf bank_mask:0xf
v_mov_b32 v36, v8
s_mov_b64 exec, s[58:59]
global_store_dwordx4 v26, v[32:35], s[30:31] sc1
s_mov_b64 exec, -1
s_mov_b32 s90, 1600000
L_wp:
s_sleep 8
ds_read_b32 v9, v28 offset:128
s_waitcnt lgkmcnt(0)
v_readfirstlane_b32 s41, v9
s_nop 1
s_cmp_lg_u32 s41, 0
s_cbranch_scc1 L_wp_ok
s_sub_u32 s90, s90, 1
s_cbranch_scc0 L_wp
L_wp_ok:
s_mov_b32 s90, 400000
s_mov_b64 exec, 0xff
L_ml:
global_load_dwordx4 v[8:11], v26, s[30:31] sc1
s_waitcnt vmcnt(0)
v_xor_b32 v9, s92, v9
v_xor_b32 v11, s93, v11
v_or_b32 v9, v9, v11
v_cmp_ne_u32 vcc, 0, v9
s_nop 1
s_cmp_eq_u64 vcc, 0
s_cbranch_scc1 L_ml_ok
s_sleep 10
s_sub_u32 s90, s90, 1
s_cbranch_scc0 L_ml
L_ml_ok:
v_mov_b32 v32, v8
s_nop 1
v_max_f32_dpp v32, v32, v32 quad_perm:[1,0,3,2] row_mask:0xf bank_mask:0xf
s_nop 1
v_max_f32_dpp v32, v32, v32 quad_perm:[2,3,0,1] row_mask:0xf bank_mask:0xf
v_sub_f32 v8, v8, v32
v_exp_f32 v8, v8
s_nop 0
v_mul_f32 v34, v10, v8
s_nop 1
v_add_f32_dpp v34, v34, v34 quad_perm:[1,0,3,2] row_mask:0xf bank_mask:0xf
s_nop 1
v_add_f32_dpp v34, v34, v34 quad_perm:[2,3,0,1] row_mask:0xf bank_mask:0xf
v_rcp_f32 v34, v34
v_mul_f32 v8, v30, v8
v_mul_f32 v8, v8, v34
s_mov_b64 exec, s[58:59]
ds_write_b32 v29, v8 offset:32
v_readlane_b32 s41, v8, s37
s_mov_b64 exec, 0xf
s_nop 0
v_mul_f32 v36, s41, v36
ds_write_b32 v27, v36 offset:48
s_mov_b64 exec, -1
s_waitcnt lgkmcnt(0)
s_barrier
L_end:
s_endpgm
L_comp:
s_sub_u32 s39, s38, 1
s_lshl_b32 s75, s36, 5
s_add_u32 s75, s75, s34
s_lshl_b32 s40, s75, 20
s_lshl_b32 s41, s37, 16
s_add_u32 s41, s41, s40
s_add_u32 s41, s41, 786432
v_lshrrev_b32 v1, 2, v17
v_lshlrev_b32 v1, 8, v1
v_lshl_add_u32 v1, v16, 6, v1
v_and_b32 v3, 3, v0
v_lshl_add_u32 v1, v3, 4, v1
v_lshlrev_b32 v2, 4, v0
v_lshlrev_b32 v4, 4, v17
v_lshlrev_b32 v84, 6, v16
v_xor_b32 v4, v4, v84
v_lshl_add_u32 v4, v16, 10, v4
s_movk_i32 s72, 0x1000
s_mov_b32 s73, 0x3ffff
s_mov_b32 s83, 0xffff
s_mul_i32 s74, s2, 37
s_add_u32 s74, s74, s39
s_lshl_b32 s74, s74, 10
s_and_b32 s74, s74, s83
s_lshl_b32 s75, s39, 10
s_and_b32 s75, s75, s73
s_mov_b32 s54, 0x10000
s_mov_b32 s55, 0x20000
s_mov_b32 s58, 0x10000
s_mov_b32 s59, 0x20000
s_mov_b32 s62, 0x20000
s_mov_b32 s63, 0x20000
s_lshl_b32 s42, s34, 17
s_lshl_b32 s43, s39, 8
s_add_u32 s42, s42, s43
s_mul_i32 s79, s39, 33280
s_mul_i32 s77, s39, 6144
s_add_u32 s77, s77, 138416
s_lshl_b32 s80, s37, 18
s_add_u32 s80, s80, s40
s_lshl2_add_u32 s81, s34, s37
s_lshl_b32 s81, s81, 11
s_lshl_b32 s43, s36, 18
s_add_u32 s81, s81, s43
s_add_u32 s81, s81, 1048576
s_waitcnt lgkmcnt(0)
s_add_u32 s52, s16, s41
s_addc_u32 s53, s17, 0
s_add_u32 s56, s18, s41
s_addc_u32 s57, s19, 0
s_add_u32 s60, s22, s42
s_addc_u32 s61, s23, 0
s_add_u32 s44, s6, s80
s_addc_u32 s45, s7, 0
s_add_u32 s48, s8, s80
s_addc_u32 s49, s9, 0
s_add_u32 s84, s12, s42
s_addc_u32 s85, s13, 0
s_add_u32 s68, s30, s81
s_addc_u32 s69, s31, 0
s_mov_b32 s92, s26
s_mov_b32 s93, s27
s_mov_b32 s46, 0x40000
s_mov_b32 s47, 0x20000
s_mov_b32 s50, 0x40000
s_mov_b32 s51, 0x20000
s_mov_b32 s86, 0x20000
s_mov_b32 s87, 0x20000
v_and_b32 v84, 1, v17
v_lshlrev_b32 v84, 4, v84
v_mov_b32 v85, 0xffff
v_lshlrev_b32 v84, v84, v85
v_lshrrev_b32 v85, 1, v17
v_cmp_eq_u32 vcc, 0, v85
s_nop 1
v_cndmask_b32 v5, 0, v84, vcc
v_cmp_eq_u32 vcc, 1, v85
s_nop 1
v_cndmask_b32 v6, 0, v84, vcc
v_cmp_eq_u32 vcc, 2, v85
s_nop 1
v_cndmask_b32 v7, 0, v84, vcc
v_cmp_eq_u32 vcc, 3, v85
s_nop 1
v_cndmask_b32 v8, 0, v84, vcc
s_mul_i32 s43, s39, 576
s_add_u32 s43, s43, 133120
v_lshrrev_b32 v9, 1, v16
v_lshlrev_b32 v9, 8, v9
v_lshl_add_u32 v9, v17, 4, v9
v_and_b32 v84, 1, v16
v_lshl_add_u32 v9, v84, 3, v9
v_add_u32 v9, s43, v9
v_mul_u32_u24 v10, 576, v3
v_lshl_add_u32 v10, v16, 4, v10
v_add_u32 v10, 133120, v10
v_lshl_add_u32 v53, v16, 2, v3
v_lshlrev_b32 v53, 4, v53
v_add_u32 v53, 137728, v53
v_lshrrev_b32 v85, 2, v17
v_mul_u32_u24 v86, 2080, v16
v_lshl_add_u32 v86, v85, 8, v86
v_lshl_add_u32 v86, v3, 3, v86
v_add_u32 v86, s79, v86
v_xor_b32 v87, 0, v85
v_lshl_add_u32 v11, v87, 6, v86
v_xor_b32 v87, 1, v85
v_lshl_add_u32 v12, v87, 6, v86
v_xor_b32 v87, 2, v85
v_lshl_add_u32 v13, v87, 6, v86
v_xor_b32 v87, 3, v85
v_lshl_add_u32 v14, v87, 6, v86
s_lshl_b32 s43, s39, 9
v_add_u32 v15, s43, v2
v_lshrrev_b32 v87, 5, v0
v_lshl_add_u32 v15, v87, 30, v15
s_movk_i32 s70, 0x800
s_mov_b32 s71, 0x20000
s_movk_i32 s82, 0x3ff
s_lshr_b32 s88, s32, 1
s_lshl_b32 s88, s88, 4
s_lshr_b32 s43, s33, 1
s_add_u32 s88, s88, s43
s_or_b32 s89, s32, s33
s_and_b32 s89, s89, 1
s_lshl2_add_u32 s88, s88, s39
s_lshr_b32 s78, s88, 7
s_lshl_b32 s78, s78, 18
s_and_b32 s43, s88, 127
s_lshl4_add_u32 s78, s43, s78
s_add_u32 s78, s78, 1048576
v_lshlrev_b32 v54, 11, v0
v_add_u32 v54, s78, v54
s_lshr_b32 s78, s88, 4
s_lshl_b32 s78, s78, 7
s_and_b32 s43, s88, 15
s_lshl1_add_u32 s78, s43, s78
v_lshlrev_b32 v55, 5, v16
v_lshl_add_u32 v55, v17, 20, v55
v_add_u32 v55, s78, v55
s_movk_i32 s94, 0x800
s_mov_b32 s95, 0x20000
s_mov_b32 s90, 400000
s_lshl2_add_u32 s64, s39, 138240
s_mov_b32 s65, 0x3db504f3
s_mov_b32 s66, 0x3fb8aa3b
s_mov_b32 s67, 0xffff0000
v_mov_b32 v52, 138240
v_mov_b32 v20, 0
v_mov_b32 v21, 0
v_mov_b32 v22, 0
v_mov_b32 v23, 0
v_mov_b32 v24, 0
v_mov_b32 v25, 0
v_mov_b32 v26, 0
v_mov_b32 v27, 0
v_mov_b32 v28, 0
v_mov_b32 v29, 0
v_mov_b32 v30, 0
v_mov_b32 v31, 0
v_mov_b32 v32, 0
v_mov_b32 v33, 0
v_mov_b32 v34, 0
v_mov_b32 v35, 0
v_mov_b32 v76, 0
v_mov_b32 v77, 0
v_mov_b32 v78, 0
v_mov_b32 v79, 0
v_mov_b32 v72, 0
v_mov_b32 v73, 0
v_mov_b32 v74, 0
v_mov_b32 v75, 0
buffer_load_dwordx4 v[128:131], v1, s[52:55], s74 offen nt
s_add_u32 s74, s74, s72
s_and_b32 s74, s74, s83
buffer_load_dwordx4 v[132:135], v1, s[52:55], s74 offen nt
s_add_u32 s74, s74, s72
s_and_b32 s74, s74, s83
s_add_u32 m0, s79, 0
s_mov_b32 s78, 0
buffer_load_dwordx4 v4, s[60:63], s78 offen  lds
buffer_load_dwordx4 v[136:139], v1, s[52:55], s74 offen nt
s_add_u32 s74, s74, s72
s_and_b32 s74, s74, s83
buffer_load_dwordx4 v[140:143], v1, s[52:55], s74 offen nt
s_add_u32 s74, s74, s72
s_and_b32 s74, s74, s83
s_add_u32 m0, s79, 1024
s_mov_b32 s78, 4096
buffer_load_dwordx4 v4, s[60:63], s78 offen  lds
buffer_load_dwordx4 v[144:147], v1, s[52:55], s74 offen nt
s_add_u32 s74, s74, s72
s_and_b32 s74, s74, s83
buffer_load_dwordx4 v[148:151], v1, s[52:55], s74 offen nt
s_add_u32 s74, s74, s72
s_and_b32 s74, s74, s83
buffer_load_dwordx4 v[152:155], v1, s[52:55], s74 offen nt
s_add_u32 s74, s74, s72
s_and_b32 s74, s74, s83
s_add_u32 m0, s79, 2080
s_mov_b32 s78, 8192
buffer_load_dwordx4 v4, s[60:63], s78 offen  lds
buffer_load_dwordx4 v[156:159], v1, s[52:55], s74 offen nt
s_add_u32 s74, s74, s72
s_and_b32 s74, s74, s83
s_waitcnt vmcnt(10)
buffer_load_dwordx4 v[160:163], v1, s[52:55], s74 offen nt
s_add_u32 s74, s74, s72
s_and_b32 s74, s74, s83
s_waitcnt vmcnt(10)
s_add_u32 m0, s79, 3104
s_mov_b32 s78, 12288
buffer_load_dwordx4 v4, s[60:63], s78 offen  lds
s_waitcnt vmcnt(10)
buffer_load_dwordx4 v[164:167], v1, s[52:55], s74 offen nt
s_add_u32 s74, s74, s72
s_and_b32 s74, s74, s83
s_waitcnt vmcnt(10)
buffer_load_dwordx4 v[168:171], v1, s[52:55], s74 offen nt
s_add_u32 s74, s74, s72
s_and_b32 s74, s74, s83
s_waitcnt vmcnt(10)
buffer_load_dwordx4 v[172:175], v1, s[52:55], s74 offen nt
s_add_u32 s74, s74, s72
s_and_b32 s74, s74, s83
s_waitcnt vmcnt(10)
s_add_u32 m0, s79, 4160
s_mov_b32 s78, 16384
buffer_load_dwordx4 v4, s[60:63], s78 offen  lds
s_waitcnt vmcnt(10)
buffer_load_dwordx4 v[176:179], v1, s[52:55], s74 offen nt
s_add_u32 s74, s74, s72
s_and_b32 s74, s74, s83
s_waitcnt vmcnt(10)
buffer_load_dwordx4 v[180:183], v1, s[52:55], s74 offen nt
s_add_u32 s74, s74, s72
s_and_b32 s74, s74, s83
s_waitcnt vmcnt(10)
s_add_u32 m0, s79, 5184
s_mov_b32 s78, 20480
buffer_load_dwordx4 v4, s[60:63], s78 offen  lds
s_waitcnt vmcnt(10)
buffer_load_dwordx4 v[184:187], v1, s[52:55], s74 offen nt
s_add_u32 s74, s74, s72
s_and_b32 s74, s74, s83
s_waitcnt vmcnt(10)
buffer_load_dwordx4 v[188:191], v1, s[52:55], s74 offen nt
s_add_u32 s74, s74, s72
s_and_b32 s74, s74, s83
s_waitcnt vmcnt(10)
buffer_load_dwordx4 v[192:195], v2, s[56:59], s74 offen nt
s_add_u32 s74, s74, s72
s_and_b32 s74, s74, s83
s_waitcnt vmcnt(10)
s_add_u32 m0, s79, 6240
s_mov_b32 s78, 24576
buffer_load_dwordx4 v4, s[60:63], s78 offen  lds
s_waitcnt vmcnt(10)
buffer_load_dwordx4 v[196:199], v2, s[56:59], s74 offen nt
s_add_u32 s74, s74, s72
s_and_b32 s74, s74, s83
s_waitcnt vmcnt(10)
buffer_load_dwordx4 v[200:203], v2, s[56:59], s74 offen nt
s_add_u32 s74, s74, s72
s_and_b32 s74, s74, s83
s_waitcnt vmcnt(10)
s_add_u32 m0, s79, 7264
s_mov_b32 s78, 28672
buffer_load_dwordx4 v4, s[60:63], s78 offen  lds
s_waitcnt vmcnt(10)
buffer_load_dwordx4 v[204:207], v2, s[56:59], s74 offen nt
s_add_u32 s74, s74, s72
s_and_b32 s74, s74, s83
s_waitcnt vmcnt(10)
buffer_load_dwordx4 v[208:211], v2, s[56:59], s74 offen nt
s_add_u32 s74, s74, s72
s_and_b32 s74, s74, s83
s_waitcnt vmcnt(10)
buffer_load_dwordx4 v[212:215], v2, s[56:59], s74 offen nt
s_add_u32 s74, s74, s72
s_and_b32 s74, s74, s83
s_waitcnt vmcnt(10)
s_add_u32 m0, s79, 8320
s_mov_b32 s78, 32768
buffer_load_dwordx4 v4, s[60:63], s78 offen  lds
s_waitcnt vmcnt(10)
buffer_load_dwordx4 v[216:219], v2, s[56:59], s74 offen nt
s_add_u32 s74, s74, s72
s_and_b32 s74, s74, s83
s_waitcnt vmcnt(10)
buffer_load_dwordx4 v[220:223], v2, s[56:59], s74 offen nt
s_add_u32 s74, s74, s72
s_and_b32 s74, s74, s83
s_waitcnt vmcnt(10)
s_add_u32 m0, s79, 9344
s_mov_b32 s78, 36864
buffer_load_dwordx4 v4, s[60:63], s78 offen  lds
s_waitcnt vmcnt(10)
buffer_load_dwordx4 v[224:227], v2, s[56:59], s74 offen nt
s_add_u32 s74, s74, s72
s_and_b32 s74, s74, s83
s_waitcnt vmcnt(10)
buffer_load_dwordx4 v[228:231], v2, s[56:59], s74 offen nt
s_add_u32 s74, s74, s72
s_and_b32 s74, s74, s83
s_waitcnt vmcnt(10)
buffer_load_dwordx4 v[232:235], v2, s[56:59], s74 offen nt
s_add_u32 s74, s74, s72
s_and_b32 s74, s74, s83
s_waitcnt vmcnt(10)
s_add_u32 m0, s79, 10400
s_mov_b32 s78, 40960
buffer_load_dwordx4 v4, s[60:63], s78 offen  lds
s_waitcnt vmcnt(10)
buffer_load_dwordx4 v[236:239], v2, s[56:59], s74 offen nt
s_add_u32 s74, s74, s72
s_and_b32 s74, s74, s83
s_waitcnt vmcnt(10)
buffer_load_dwordx4 v[240:243], v2, s[56:59], s74 offen nt
s_add_u32 s74, s74, s72
s_and_b32 s74, s74, s83
s_waitcnt vmcnt(10)
buffer_load_dwordx4 v[244:247], v2, s[56:59], s74 offen nt
s_add_u32 s74, s74, s72
s_and_b32 s74, s74, s83
s_waitcnt vmcnt(10)
s_add_u32 m0, s79, 11424
s_mov_b32 s78, 45056
buffer_load_dwordx4 v4, s[60:63], s78 offen  lds
s_waitcnt vmcnt(10)
buffer_load_dwordx4 v[248:251], v2, s[56:59], s74 offen nt
s_add_u32 s74, s74, s72
s_and_b32 s74, s74, s83
s_waitcnt vmcnt(10)
buffer_load_dwordx4 v[252:255], v2, s[56:59], s74 offen nt
s_add_u32 s74, s74, s72
s_and_b32 s74, s74, s83
s_waitcnt vmcnt(10)
s_add_u32 m0, s79, 12480
s_mov_b32 s78, 49152
buffer_load_dwordx4 v4, s[60:63], s78 offen  lds
s_waitcnt vmcnt(10)
s_add_u32 m0, s77, 0
s_nop 0
buffer_load_dwordx4 v1, s[44:47], s75 offen nt lds
s_add_u32 s75, s75, s72
s_and_b32 s75, s75, s73
s_waitcnt vmcnt(10)
s_add_u32 m0, s77, 1024
s_nop 0
buffer_load_dwordx4 v1, s[44:47], s75 offen nt lds
s_add_u32 s75, s75, s72
s_and_b32 s75, s75, s73
s_waitcnt vmcnt(10)
s_add_u32 m0, s77, 2048
s_nop 0
buffer_load_dwordx4 v1, s[44:47], s75 offen nt lds
s_add_u32 s75, s75, s72
s_and_b32 s75, s75, s73
s_waitcnt vmcnt(10)
s_add_u32 m0, s79, 13504
s_mov_b32 s78, 53248
buffer_load_dwordx4 v4, s[60:63], s78 offen  lds
s_waitcnt vmcnt(10)
s_add_u32 m0, s77, 3072
s_nop 0
buffer_load_dwordx4 v1, s[44:47], s75 offen nt lds
s_add_u32 s75, s75, s72
s_and_b32 s75, s75, s73
s_waitcnt vmcnt(10)
s_add_u32 m0, s77, 4096
s_nop 0
buffer_load_dwordx4 v1, s[44:47], s75 offen nt lds
s_add_u32 s75, s75, s72
s_and_b32 s75, s75, s73
s_waitcnt vmcnt(10)
s_add_u32 m0, s79, 14560
s_mov_b32 s78, 57344
buffer_load_dwordx4 v4, s[60:63], s78 offen  lds
s_waitcnt vmcnt(10)
s_add_u32 m0, s77, 5120
s_nop 0
buffer_load_dwordx4 v1, s[44:47], s75 offen nt lds
s_add_u32 s75, s75, s72
s_and_b32 s75, s75, s73
s_waitcnt vmcnt(10)
s_add_u32 m0, s79, 22880
s_nop 0
buffer_load_dwordx4 v1, s[44:47], s75 offen nt lds
s_add_u32 s75, s75, s72
s_and_b32 s75, s75, s73
s_waitcnt vmcnt(10)
s_add_u32 m0, s79, 23904
s_nop 0
buffer_load_dwordx4 v1, s[44:47], s75 offen nt lds
s_add_u32 s75, s75, s72
s_and_b32 s75, s75, s73
s_waitcnt vmcnt(10)
s_add_u32 m0, s79, 15584
s_mov_b32 s78, 61440
buffer_load_dwordx4 v4, s[60:63], s78 offen  lds
s_waitcnt vmcnt(10)
s_add_u32 m0, s79, 24928
s_nop 0
buffer_load_dwordx4 v1, s[44:47], s75 offen nt lds
s_add_u32 s75, s75, s72
s_and_b32 s75, s75, s73
s_waitcnt vmcnt(10)
s_add_u32 m0, s79, 25952
s_nop 0
buffer_load_dwordx4 v1, s[44:47], s75 offen nt lds
s_add_u32 s75, s75, s72
s_and_b32 s75, s75, s73
s_waitcnt vmcnt(10)
s_add_u32 m0, s79, 16640
s_mov_b32 s78, 65536
buffer_load_dwordx4 v4, s[60:63], s78 offen  lds
s_waitcnt vmcnt(10)
s_add_u32 m0, s79, 26976
s_nop 0
buffer_load_dwordx4 v1, s[44:47], s75 offen nt lds
s_add_u32 s75, s75, s72
s_and_b32 s75, s75, s73
s_waitcnt vmcnt(10)
s_add_u32 m0, s79, 28000
s_nop 0
buffer_load_dwordx4 v1, s[44:47], s75 offen nt lds
s_add_u32 s75, s75, s72
s_and_b32 s75, s75, s73
s_waitcnt vmcnt(10)
s_add_u32 m0, s79, 29024
s_nop 0
buffer_load_dwordx4 v1, s[44:47], s75 offen nt lds
s_add_u32 s75, s75, s72
s_and_b32 s75, s75, s73
s_waitcnt vmcnt(10)
s_add_u32 m0, s79, 17664
s_mov_b32 s78, 69632
buffer_load_dwordx4 v4, s[60:63], s78 offen  lds
s_waitcnt vmcnt(10)
s_add_u32 m0, s79, 30048
s_nop 0
buffer_load_dwordx4 v1, s[44:47], s75 offen nt lds
s_add_u32 s75, s75, s72
s_and_b32 s75, s75, s73
s_waitcnt vmcnt(10)
s_add_u32 m0, s79, 31072
s_nop 0
buffer_load_dwordx4 v1, s[44:47], s75 offen nt lds
s_add_u32 s75, s75, s72
s_and_b32 s75, s75, s73
s_waitcnt vmcnt(10)
s_add_u32 m0, s79, 18720
s_mov_b32 s78, 73728
buffer_load_dwordx4 v4, s[60:63], s78 offen  lds
s_waitcnt vmcnt(10)
s_add_u32 m0, s79, 32096
s_nop 0
buffer_load_dwordx4 v1, s[44:47], s75 offen nt lds
s_add_u32 s75, s75, s72
s_and_b32 s75, s75, s73
s_barrier
ds_read_b128 v[84:87], v53 offset:256
s_waitcnt lgkmcnt(0)
v_mov_b32_dpp v20, v84 quad_perm:[0,1,2,3] row_mask:0xf bank_mask:0x1
v_mov_b32_dpp v21, v85 quad_perm:[0,1,2,3] row_mask:0xf bank_mask:0x1
v_mov_b32_dpp v22, v86 quad_perm:[0,1,2,3] row_mask:0xf bank_mask:0x1
v_mov_b32_dpp v23, v87 quad_perm:[0,1,2,3] row_mask:0xf bank_mask:0x1
v_mov_b32_dpp v24, v84 quad_perm:[0,1,2,3] row_mask:0xf bank_mask:0x2
v_mov_b32_dpp v25, v85 quad_perm:[0,1,2,3] row_mask:0xf bank_mask:0x2
v_mov_b32_dpp v26, v86 quad_perm:[0,1,2,3] row_mask:0xf bank_mask:0x2
v_mov_b32_dpp v27, v87 quad_perm:[0,1,2,3] row_mask:0xf bank_mask:0x2
v_mov_b32_dpp v28, v84 quad_perm:[0,1,2,3] row_mask:0xf bank_mask:0x4
v_mov_b32_dpp v29, v85 quad_perm:[0,1,2,3] row_mask:0xf bank_mask:0x4
v_mov_b32_dpp v30, v86 quad_perm:[0,1,2,3] row_mask:0xf bank_mask:0x4
v_mov_b32_dpp v31, v87 quad_perm:[0,1,2,3] row_mask:0xf bank_mask:0x4
v_mov_b32_dpp v32, v84 quad_perm:[0,1,2,3] row_mask:0xf bank_mask:0x8
v_mov_b32_dpp v33, v85 quad_perm:[0,1,2,3] row_mask:0xf bank_mask:0x8
v_mov_b32_dpp v34, v86 quad_perm:[0,1,2,3] row_mask:0xf bank_mask:0x8
v_mov_b32_dpp v35, v87 quad_perm:[0,1,2,3] row_mask:0xf bank_mask:0x8
s_waitcnt vmcnt(63)
v_mfma_f32_16x16x32_bf16 v[64:67], v[128:131], v[20:23], 0
buffer_load_dwordx4 v[128:131], v1, s[44:47], s75 offen nt
s_add_u32 s75, s75, s72
s_and_b32 s75, s75, s73
s_waitcnt vmcnt(63)
v_mfma_f32_16x16x32_bf16 v[64:67], v[132:135], v[24:27], v[64:67]
buffer_load_dwordx4 v[132:135], v1, s[44:47], s75 offen nt
s_add_u32 s75, s75, s72
s_and_b32 s75, s75, s73
s_waitcnt vmcnt(63)
v_mfma_f32_16x16x32_bf16 v[64:67], v[136:139], v[28:31], v[64:67]
s_waitcnt vmcnt(63)
v_mfma_f32_16x16x32_bf16 v[64:67], v[140:143], v[32:35], v[64:67]
s_waitcnt vmcnt(62)
v_mfma_f32_16x16x32_bf16 v[68:71], v[144:147], v[20:23], 0
s_waitcnt vmcnt(61)
v_mfma_f32_16x16x32_bf16 v[68:71], v[148:151], v[24:27], v[68:71]
s_waitcnt vmcnt(60)
v_mfma_f32_16x16x32_bf16 v[68:71], v[152:155], v[28:31], v[68:71]
buffer_load_dwordx4 v[136:139], v1, s[44:47], s75 offen nt
s_add_u32 s75, s75, s72
s_and_b32 s75, s75, s73
s_waitcnt vmcnt(59)
v_mfma_f32_16x16x32_bf16 v[68:71], v[156:159], v[32:35], v[68:71]
v_mov_b32_dpp v36, v64 quad_perm:[0,0,0,0] row_mask:0xf bank_mask:0xf
v_add_f32_dpp v36, v65, v36 quad_perm:[1,1,1,1] row_mask:0xf bank_mask:0xf
v_add_f32_dpp v36, v66, v36 quad_perm:[2,2,2,2] row_mask:0xf bank_mask:0xf
v_add_f32_dpp v36, v67, v36 quad_perm:[3,3,3,3] row_mask:0xf bank_mask:0xf
s_waitcnt vmcnt(58)
v_mfma_f32_16x16x32_bf16 v[64:67], v[160:163], v[20:23], 0
s_waitcnt vmcnt(56)
v_mfma_f32_16x16x32_bf16 v[64:67], v[164:167], v[24:27], v[64:67]
s_waitcnt vmcnt(55)
v_mfma_f32_16x16x32_bf16 v[64:67], v[168:171], v[28:31], v[64:67]
s_waitcnt vmcnt(54)
buffer_load_dwordx4 v[140:143], v1, s[44:47], s75 offen nt
s_add_u32 s75, s75, s72
s_and_b32 s75, s75, s73
v_mfma_f32_16x16x32_bf16 v[64:67], v[172:175], v[32:35], v[64:67]
v_mov_b32_dpp v37, v68 quad_perm:[0,0,0,0] row_mask:0xf bank_mask:0xf
v_add_f32_dpp v37, v69, v37 quad_perm:[1,1,1,1] row_mask:0xf bank_mask:0xf
v_add_f32_dpp v37, v70, v37 quad_perm:[2,2,2,2] row_mask:0xf bank_mask:0xf
v_add_f32_dpp v37, v71, v37 quad_perm:[3,3,3,3] row_mask:0xf bank_mask:0xf
s_waitcnt vmcnt(53)
v_mfma_f32_16x16x32_bf16 v[68:71], v[176:179], v[20:23], 0
s_waitcnt vmcnt(52)
v_mfma_f32_16x16x32_bf16 v[68:71], v[180:183], v[24:27], v[68:71]
s_waitcnt vmcnt(50)
v_mfma_f32_16x16x32_bf16 v[68:71], v[184:187], v[28:31], v[68:71]
s_waitcnt vmcnt(49)
v_mfma_f32_16x16x32_bf16 v[68:71], v[188:191], v[32:35], v[68:71]
buffer_load_dwordx4 v[144:147], v1, s[44:47], s75 offen nt
s_add_u32 s75, s75, s72
s_and_b32 s75, s75, s73
v_mov_b32_dpp v38, v64 quad_perm:[0,0,0,0] row_mask:0xf bank_mask:0xf
v_add_f32_dpp v38, v65, v38 quad_perm:[1,1,1,1] row_mask:0xf bank_mask:0xf
v_add_f32_dpp v38, v66, v38 quad_perm:[2,2,2,2] row_mask:0xf bank_mask:0xf
v_add_f32_dpp v38, v67, v38 quad_perm:[3,3,3,3] row_mask:0xf bank_mask:0xf
s_nop 3
v_mov_b32_dpp v39, v68 quad_perm:[0,0,0,0] row_mask:0xf bank_mask:0xf
v_add_f32_dpp v39, v69, v39 quad_perm:[1,1,1,1] row_mask:0xf bank_mask:0xf
v_add_f32_dpp v39, v70, v39 quad_perm:[2,2,2,2] row_mask:0xf bank_mask:0xf
v_add_f32_dpp v39, v71, v39 quad_perm:[3,3,3,3] row_mask:0xf bank_mask:0xf
v_cvt_pk_bf16_f32 v84, v36, v37
v_cvt_pk_bf16_f32 v85, v38, v39
v_lshlrev_b32 v36, 16, v84
v_and_b32 v37, s67, v84
v_lshlrev_b32 v38, 16, v85
v_and_b32 v39, s67, v85
v_mul_f32 v36, s65, v36
v_mul_f32 v37, s65, v37
v_mul_f32 v38, s65, v38
v_mul_f32 v39, s65, v39
v_cvt_pk_bf16_f32 v84, v36, v37
v_cvt_pk_bf16_f32 v85, v38, v39
v_lshlrev_b32 v36, 16, v84
v_and_b32 v37, s67, v84
v_lshlrev_b32 v38, 16, v85
v_and_b32 v39, s67, v85
v_max3_f32 v84, v36, v37, v38
v_max_f32 v84, v84, v39
buffer_load_dwordx4 v[148:151], v1, s[44:47], s75 offen nt
s_add_u32 s75, s75, s72
s_and_b32 s75, s75, s73
s_nop 1
v_max_f32_dpp v84, v84, v84 row_ror:4 row_mask:0xf bank_mask:0xf
s_nop 1
v_max_f32_dpp v84, v84, v84 row_ror:8 row_mask:0xf bank_mask:0xf
s_nop 1
v_max_f32_dpp v84, v84, v84 row_bcast:15 row_mask:0xa bank_mask:0xf
s_nop 1
v_max_f32_dpp v84, v84, v84 row_bcast:31 row_mask:0xc bank_mask:0xf
s_nop 1
v_readlane_b32 s80, v84, 63
v_mov_b32 v86, s66
s_nop 1
v_mul_f32 v86, s80, v86
v_fma_f32 v36, v36, s66, -v86
v_fma_f32 v37, v37, s66, -v86
v_fma_f32 v38, v38, s66, -v86
v_fma_f32 v39, v39, s66, -v86
v_exp_f32 v36, v36
v_exp_f32 v37, v37
v_exp_f32 v38, v38
v_exp_f32 v39, v39
v_add_f32 v87, v36, v37
v_add_f32 v87, v87, v38
v_add_f32 v87, v87, v39
buffer_load_dwordx4 v[152:155], v1, s[44:47], s75 offen nt
s_add_u32 s75, s75, s72
s_and_b32 s75, s75, s73
v_cvt_pk_bf16_f32 v36, v36, v36
v_cvt_pk_bf16_f32 v37, v37, v37
v_cvt_pk_bf16_f32 v38, v38, v38
v_cvt_pk_bf16_f32 v39, v39, v39
s_nop 1
v_add_f32_dpp v87, v87, v87 row_ror:4 row_mask:0xf bank_mask:0xf
s_nop 1
v_add_f32_dpp v87, v87, v87 row_ror:8 row_mask:0xf bank_mask:0xf
s_nop 1
v_add_f32_dpp v87, v87, v87 row_bcast:15 row_mask:0xa bank_mask:0xf
s_nop 1
v_add_f32_dpp v87, v87, v87 row_bcast:31 row_mask:0xc bank_mask:0xf
v_mov_b32 v84, s64
s_mov_b32 exec_lo, 0
s_mov_b32 exec_hi, 0x80000000
ds_write2_b32 v84, v86, v87 offset0:16 offset1:20
s_mov_b64 exec, -1
ds_read_b128 v[84:87], v53 offset:0
s_waitcnt lgkmcnt(0)
v_mov_b32_dpp v20, v84 quad_perm:[0,1,2,3] row_mask:0xf bank_mask:0x1
v_mov_b32_dpp v21, v85 quad_perm:[0,1,2,3] row_mask:0xf bank_mask:0x1
v_mov_b32_dpp v22, v86 quad_perm:[0,1,2,3] row_mask:0xf bank_mask:0x1
buffer_load_dwordx4 v[156:159], v1, s[44:47], s75 offen nt
s_add_u32 s75, s75, s72
s_and_b32 s75, s75, s73
v_mov_b32_dpp v23, v87 quad_perm:[0,1,2,3] row_mask:0xf bank_mask:0x1
v_mov_b32_dpp v24, v84 quad_perm:[0,1,2,3] row_mask:0xf bank_mask:0x2
v_mov_b32_dpp v25, v85 quad_perm:[0,1,2,3] row_mask:0xf bank_mask:0x2
v_mov_b32_dpp v26, v86 quad_perm:[0,1,2,3] row_mask:0xf bank_mask:0x2
v_mov_b32_dpp v27, v87 quad_perm:[0,1,2,3] row_mask:0xf bank_mask:0x2
v_mov_b32_dpp v28, v84 quad_perm:[0,1,2,3] row_mask:0xf bank_mask:0x4
v_mov_b32_dpp v29, v85 quad_perm:[0,1,2,3] row_mask:0xf bank_mask:0x4
v_mov_b32_dpp v30, v86 quad_perm:[0,1,2,3] row_mask:0xf bank_mask:0x4
v_mov_b32_dpp v31, v87 quad_perm:[0,1,2,3] row_mask:0xf bank_mask:0x4
v_mov_b32_dpp v32, v84 quad_perm:[0,1,2,3] row_mask:0xf bank_mask:0x8
v_mov_b32_dpp v33, v85 quad_perm:[0,1,2,3] row_mask:0xf bank_mask:0x8
v_mov_b32_dpp v34, v86 quad_perm:[0,1,2,3] row_mask:0xf bank_mask:0x8
v_mov_b32_dpp v35, v87 quad_perm:[0,1,2,3] row_mask:0xf bank_mask:0x8
v_add_u32 v84, s79, v2
v_add_u32 v85, s77, v2
s_waitcnt vmcnt(8)
ds_read_b128 v[100:103], v85 offset:0
ds_read_b128 v[104:107], v85 offset:1024
ds_read_b128 v[108:111], v85 offset:2048
ds_read_b128 v[112:115], v85 offset:3072
ds_read_b128 v[116:119], v85 offset:4096
ds_read_b128 v[120:123], v85 offset:5120
s_waitcnt lgkmcnt(5)
v_mfma_f32_16x16x32_bf16 v[64:67], v[100:103], v[20:23], 0
buffer_load_dwordx4 v[160:163], v1, s[44:47], s75 offen nt
s_add_u32 s75, s75, s72
s_and_b32 s75, s75, s73
ds_read_b128 v[124:127], v84 offset:22880
s_waitcnt lgkmcnt(5)
v_mfma_f32_16x16x32_bf16 v[64:67], v[104:107], v[24:27], v[64:67]
ds_read_b128 v[100:103], v84 offset:23904
s_waitcnt lgkmcnt(5)
v_mfma_f32_16x16x32_bf16 v[64:67], v[108:111], v[28:31], v[64:67]
buffer_load_dwordx4 v[164:167], v1, s[44:47], s75 offen nt
s_add_u32 s75, s75, s72
s_and_b32 s75, s75, s73
ds_read_b128 v[104:107], v84 offset:24928
s_waitcnt lgkmcnt(5)
v_mfma_f32_16x16x32_bf16 v[64:67], v[112:115], v[32:35], v[64:67]
ds_read_b128 v[108:111], v84 offset:25952
s_waitcnt lgkmcnt(5)
v_mfma_f32_16x16x32_bf16 v[68:71], v[116:119], v[20:23], 0
buffer_load_dwordx4 v[168:171], v1, s[44:47], s75 offen nt
s_add_u32 s75, s75, s72
s_and_b32 s75, s75, s73
ds_read_b128 v[112:115], v84 offset:26976
s_waitcnt lgkmcnt(5)
v_mfma_f32_16x16x32_bf16 v[68:71], v[120:123], v[24:27], v[68:71]
ds_read_b128 v[116:119], v84 offset:28000
s_waitcnt lgkmcnt(5)
v_mfma_f32_16x16x32_bf16 v[68:71], v[124:127], v[28:31], v[68:71]
ds_read_b128 v[120:123], v84 offset:29024
s_waitcnt lgkmcnt(5)
v_mfma_f32_16x16x32_bf16 v[68:71], v[100:103], v[32:35], v[68:71]
buffer_load_dwordx4 v[172:175], v1, s[44:47], s75 offen nt
s_add_u32 s75, s75, s72
s_and_b32 s75, s75, s73
ds_read_b128 v[124:127], v84 offset:30048
v_mov_b32_dpp v40, v64 quad_perm:[0,0,0,0] row_mask:0xf bank_mask:0xf
v_add_f32_dpp v40, v65, v40 quad_perm:[1,1,1,1] row_mask:0xf bank_mask:0xf
v_add_f32_dpp v40, v66, v40 quad_perm:[2,2,2,2] row_mask:0xf bank_mask:0xf
v_add_f32_dpp v40, v67, v40 quad_perm:[3,3,3,3] row_mask:0xf bank_mask:0xf
s_waitcnt lgkmcnt(5)
v_mfma_f32_16x16x32_bf16 v[64:67], v[104:107], v[20:23], 0
ds_read_b128 v[100:103], v84 offset:31072
buffer_load_dwordx4 v[176:179], v1, s[44:47], s75 offen nt
s_add_u32 s75, s75, s72
s_and_b32 s75, s75, s73
s_waitcnt lgkmcnt(5)
v_mfma_f32_16x16x32_bf16 v[64:67], v[108:111], v[24:27], v[64:67]
ds_read_b128 v[104:107], v84 offset:32096
s_waitcnt lgkmcnt(5)
v_mfma_f32_16x16x32_bf16 v[64:67], v[112:115], v[28:31], v[64:67]
s_waitcnt lgkmcnt(4)
v_mfma_f32_16x16x32_bf16 v[64:67], v[116:119], v[32:35], v[64:67]
buffer_load_dwordx4 v[180:183], v1, s[44:47], s75 offen nt
s_add_u32 s75, s75, s72
s_and_b32 s75, s75, s73
v_mov_b32_dpp v41, v68 quad_perm:[0,0,0,0] row_mask:0xf bank_mask:0xf
v_add_f32_dpp v41, v69, v41 quad_perm:[1,1,1,1] row_mask:0xf bank_mask:0xf
v_add_f32_dpp v41, v70, v41 quad_perm:[2,2,2,2] row_mask:0xf bank_mask:0xf
v_add_f32_dpp v41, v71, v41 quad_perm:[3,3,3,3] row_mask:0xf bank_mask:0xf
s_waitcnt lgkmcnt(3)
v_mfma_f32_16x16x32_bf16 v[68:71], v[120:123], v[20:23], 0
s_waitcnt lgkmcnt(2)
v_mfma_f32_16x16x32_bf16 v[68:71], v[124:127], v[24:27], v[68:71]
buffer_load_dwordx4 v[184:187], v1, s[44:47], s75 offen nt
s_add_u32 s75, s75, s72
s_and_b32 s75, s75, s73
s_waitcnt lgkmcnt(1)
v_mfma_f32_16x16x32_bf16 v[68:71], v[100:103], v[28:31], v[68:71]
s_waitcnt lgkmcnt(0)
v_mfma_f32_16x16x32_bf16 v[68:71], v[104:107], v[32:35], v[68:71]
buffer_load_dwordx4 v[188:191], v1, s[44:47], s75 offen nt
s_add_u32 s75, s75, s72
s_and_b32 s75, s75, s73
v_mov_b32_dpp v42, v64 quad_perm:[0,0,0,0] row_mask:0xf bank_mask:0xf
v_add_f32_dpp v42, v65, v42 quad_perm:[1,1,1,1] row_mask:0xf bank_mask:0xf
v_add_f32_dpp v42, v66, v42 quad_perm:[2,2,2,2] row_mask:0xf bank_mask:0xf
v_add_f32_dpp v42, v67, v42 quad_perm:[3,3,3,3] row_mask:0xf bank_mask:0xf
s_nop 3
v_mov_b32_dpp v43, v68 quad_perm:[0,0,0,0] row_mask:0xf bank_mask:0xf
v_add_f32_dpp v43, v69, v43 quad_perm:[1,1,1,1] row_mask:0xf bank_mask:0xf
v_add_f32_dpp v43, v70, v43 quad_perm:[2,2,2,2] row_mask:0xf bank_mask:0xf
v_add_f32_dpp v43, v71, v43 quad_perm:[3,3,3,3] row_mask:0xf bank_mask:0xf
v_and_b32_dpp v56, v36, v5 row_newbcast:0 row_mask:0xf bank_mask:0xf
v_and_b32_dpp v57, v36, v6 row_newbcast:0 row_mask:0xf bank_mask:0xf
v_and_b32_dpp v58, v36, v7 row_newbcast:0 row_mask:0xf bank_mask:0xf
v_and_b32_dpp v59, v36, v8 row_newbcast:0 row_mask:0xf bank_mask:0xf
s_nop 0
s_nop 0
v_mfma_f32_16x16x32_bf16 v[72:75], v[56:59], v[192:195], v[72:75]
buffer_load_dwordx4 v[192:195], v1, s[44:47], s75 offen nt
s_add_u32 s75, s75, s72
s_and_b32 s75, s75, s73
s_add_u32 m0, s79, 19744
s_mov_b32 s78, 77824
buffer_load_dwordx4 v4, s[60:63], s78 offen  lds
v_and_b32_dpp v60, v36, v5 row_newbcast:4 row_mask:0xf bank_mask:0xf
v_and_b32_dpp v61, v36, v6 row_newbcast:4 row_mask:0xf bank_mask:0xf
v_and_b32_dpp v62, v36, v7 row_newbcast:4 row_mask:0xf bank_mask:0xf
v_and_b32_dpp v63, v36, v8 row_newbcast:4 row_mask:0xf bank_mask:0xf
s_nop 0
s_nop 0
v_mfma_f32_16x16x32_bf16 v[72:75], v[60:63], v[196:199], v[72:75]
buffer_load_dwordx4 v[196:199], v1, s[44:47], s75 offen nt
s_add_u32 s75, s75, s72
s_and_b32 s75, s75, s73
s_add_u32 m0, s79, 20800
s_mov_b32 s78, 81920
buffer_load_dwordx4 v4, s[60:63], s78 offen  lds
v_and_b32_dpp v56, v36, v5 row_newbcast:8 row_mask:0xf bank_mask:0xf
v_and_b32_dpp v57, v36, v6 row_newbcast:8 row_mask:0xf bank_mask:0xf
v_and_b32_dpp v58, v36, v7 row_newbcast:8 row_mask:0xf bank_mask:0xf
v_and_b32_dpp v59, v36, v8 row_newbcast:8 row_mask:0xf bank_mask:0xf
s_nop 0
s_nop 0
v_mfma_f32_16x16x32_bf16 v[72:75], v[56:59], v[200:203], v[72:75]
buffer_load_dwordx4 v[200:203], v1, s[44:47], s75 offen nt
s_add_u32 s75, s75, s72
s_and_b32 s75, s75, s73
v_and_b32_dpp v60, v36, v5 row_newbcast:12 row_mask:0xf bank_mask:0xf
v_and_b32_dpp v61, v36, v6 row_newbcast:12 row_mask:0xf bank_mask:0xf
v_and_b32_dpp v62, v36, v7 row_newbcast:12 row_mask:0xf bank_mask:0xf
v_and_b32_dpp v63, v36, v8 row_newbcast:12 row_mask:0xf bank_mask:0xf
s_nop 0
s_nop 0
v_mfma_f32_16x16x32_bf16 v[72:75], v[60:63], v[204:207], v[72:75]
buffer_load_dwordx4 v[204:207], v1, s[44:47], s75 offen nt
s_add_u32 s75, s75, s72
s_and_b32 s75, s75, s73
s_add_u32 m0, s79, 21824
s_mov_b32 s78, 86016
buffer_load_dwordx4 v4, s[60:63], s78 offen  lds
v_and_b32_dpp v56, v37, v5 row_newbcast:0 row_mask:0xf bank_mask:0xf
v_and_b32_dpp v57, v37, v6 row_newbcast:0 row_mask:0xf bank_mask:0xf
v_and_b32_dpp v58, v37, v7 row_newbcast:0 row_mask:0xf bank_mask:0xf
v_and_b32_dpp v59, v37, v8 row_newbcast:0 row_mask:0xf bank_mask:0xf
s_nop 0
s_nop 0
v_mfma_f32_16x16x32_bf16 v[72:75], v[56:59], v[208:211], v[72:75]
buffer_load_dwordx4 v[208:211], v1, s[44:47], s75 offen nt
s_add_u32 s75, s75, s72
s_and_b32 s75, s75, s73
s_add_u32 m0, s79, 22880
s_mov_b32 s78, 90112
buffer_load_dwordx4 v4, s[60:63], s78 offen  lds
v_and_b32_dpp v60, v37, v5 row_newbcast:4 row_mask:0xf bank_mask:0xf
v_and_b32_dpp v61, v37, v6 row_newbcast:4 row_mask:0xf bank_mask:0xf
v_and_b32_dpp v62, v37, v7 row_newbcast:4 row_mask:0xf bank_mask:0xf
v_and_b32_dpp v63, v37, v8 row_newbcast:4 row_mask:0xf bank_mask:0xf
s_nop 0
s_nop 0
v_mfma_f32_16x16x32_bf16 v[72:75], v[60:63], v[212:215], v[72:75]
buffer_load_dwordx4 v[212:215], v1, s[44:47], s75 offen nt
s_add_u32 s75, s75, s72
s_and_b32 s75, s75, s73
s_add_u32 m0, s79, 23904
s_mov_b32 s78, 94208
buffer_load_dwordx4 v4, s[60:63], s78 offen  lds
v_and_b32_dpp v56, v37, v5 row_newbcast:8 row_mask:0xf bank_mask:0xf
v_and_b32_dpp v57, v37, v6 row_newbcast:8 row_mask:0xf bank_mask:0xf
v_and_b32_dpp v58, v37, v7 row_newbcast:8 row_mask:0xf bank_mask:0xf
v_and_b32_dpp v59, v37, v8 row_newbcast:8 row_mask:0xf bank_mask:0xf
s_nop 0
s_nop 0
v_mfma_f32_16x16x32_bf16 v[72:75], v[56:59], v[216:219], v[72:75]
buffer_load_dwordx4 v[216:219], v1, s[44:47], s75 offen nt
s_add_u32 s75, s75, s72
s_and_b32 s75, s75, s73
v_and_b32_dpp v60, v37, v5 row_newbcast:12 row_mask:0xf bank_mask:0xf
v_and_b32_dpp v61, v37, v6 row_newbcast:12 row_mask:0xf bank_mask:0xf
s_add_u32 m0, s79, 24960
s_mov_b32 s78, 98304
buffer_load_dwordx4 v4, s[60:63], s78 offen  lds
v_and_b32_dpp v62, v37, v7 row_newbcast:12 row_mask:0xf bank_mask:0xf
v_and_b32_dpp v63, v37, v8 row_newbcast:12 row_mask:0xf bank_mask:0xf
s_nop 0
s_nop 0
v_mfma_f32_16x16x32_bf16 v[72:75], v[60:63], v[220:223], v[72:75]
buffer_load_dwordx4 v[220:223], v1, s[44:47], s75 offen nt
s_add_u32 s75, s75, s72
s_and_b32 s75, s75, s73
v_and_b32_dpp v56, v38, v5 row_newbcast:0 row_mask:0xf bank_mask:0xf
v_and_b32_dpp v57, v38, v6 row_newbcast:0 row_mask:0xf bank_mask:0xf
v_and_b32_dpp v58, v38, v7 row_newbcast:0 row_mask:0xf bank_mask:0xf
v_and_b32_dpp v59, v38, v8 row_newbcast:0 row_mask:0xf bank_mask:0xf
s_nop 0
s_add_u32 m0, s79, 25984
s_mov_b32 s78, 102400
buffer_load_dwordx4 v4, s[60:63], s78 offen  lds
s_nop 0
v_mfma_f32_16x16x32_bf16 v[72:75], v[56:59], v[224:227], v[72:75]
v_and_b32_dpp v60, v38, v5 row_newbcast:4 row_mask:0xf bank_mask:0xf
buffer_load_dwordx4 v[224:227], v1, s[44:47], s75 offen nt
s_add_u32 s75, s75, s72
s_and_b32 s75, s75, s73
v_and_b32_dpp v61, v38, v6 row_newbcast:4 row_mask:0xf bank_mask:0xf
v_and_b32_dpp v62, v38, v7 row_newbcast:4 row_mask:0xf bank_mask:0xf
v_and_b32_dpp v63, v38, v8 row_newbcast:4 row_mask:0xf bank_mask:0xf
s_nop 0
s_nop 0
v_mfma_f32_16x16x32_bf16 v[72:75], v[60:63], v[228:231], v[72:75]
buffer_load_dwordx4 v[228:231], v1, s[44:47], s75 offen nt
s_add_u32 s75, s75, s72
s_and_b32 s75, s75, s73
v_and_b32_dpp v56, v38, v5 row_newbcast:8 row_mask:0xf bank_mask:0xf
v_and_b32_dpp v57, v38, v6 row_newbcast:8 row_mask:0xf bank_mask:0xf
v_and_b32_dpp v58, v38, v7 row_newbcast:8 row_mask:0xf bank_mask:0xf
v_and_b32_dpp v59, v38, v8 row_newbcast:8 row_mask:0xf bank_mask:0xf
s_add_u32 m0, s79, 27040
s_mov_b32 s78, 106496
buffer_load_dwordx4 v4, s[60:63], s78 offen  lds
s_nop 0
s_nop 0
v_mfma_f32_16x16x32_bf16 v[72:75], v[56:59], v[232:235], v[72:75]
buffer_load_dwordx4 v[232:235], v1, s[44:47], s75 offen nt
s_add_u32 s75, s75, s72
s_and_b32 s75, s75, s73
v_and_b32_dpp v60, v38, v5 row_newbcast:12 row_mask:0xf bank_mask:0xf
v_and_b32_dpp v61, v38, v6 row_newbcast:12 row_mask:0xf bank_mask:0xf
v_and_b32_dpp v62, v38, v7 row_newbcast:12 row_mask:0xf bank_mask:0xf
v_and_b32_dpp v63, v38, v8 row_newbcast:12 row_mask:0xf bank_mask:0xf
s_nop 0
s_nop 0
v_mfma_f32_16x16x32_bf16 v[72:75], v[60:63], v[236:239], v[72:75]
s_add_u32 m0, s79, 28064
s_mov_b32 s78, 110592
buffer_load_dwordx4 v4, s[60:63], s78 offen  lds
v_and_b32_dpp v56, v39, v5 row_newbcast:0 row_mask:0xf bank_mask:0xf
v_and_b32_dpp v57, v39, v6 row_newbcast:0 row_mask:0xf bank_mask:0xf
v_and_b32_dpp v58, v39, v7 row_newbcast:0 row_mask:0xf bank_mask:0xf
buffer_load_dwordx4 v[236:239], v1, s[44:47], s75 offen nt
s_add_u32 s75, s75, s72
s_and_b32 s75, s75, s73
v_and_b32_dpp v59, v39, v8 row_newbcast:0 row_mask:0xf bank_mask:0xf
s_nop 0
s_nop 0
v_mfma_f32_16x16x32_bf16 v[72:75], v[56:59], v[240:243], v[72:75]
s_add_u32 m0, s79, 29120
s_mov_b32 s78, 114688
buffer_load_dwordx4 v4, s[60:63], s78 offen  lds
v_and_b32_dpp v60, v39, v5 row_newbcast:4 row_mask:0xf bank_mask:0xf
v_and_b32_dpp v61, v39, v6 row_newbcast:4 row_mask:0xf bank_mask:0xf
v_and_b32_dpp v62, v39, v7 row_newbcast:4 row_mask:0xf bank_mask:0xf
v_and_b32_dpp v63, v39, v8 row_newbcast:4 row_mask:0xf bank_mask:0xf
s_nop 0
s_nop 0
buffer_load_dwordx4 v[240:243], v1, s[44:47], s75 offen nt
s_add_u32 s75, s75, s72
s_and_b32 s75, s75, s73
v_mfma_f32_16x16x32_bf16 v[72:75], v[60:63], v[244:247], v[72:75]
v_and_b32_dpp v56, v39, v5 row_newbcast:8 row_mask:0xf bank_mask:0xf
v_and_b32_dpp v57, v39, v6 row_newbcast:8 row_mask:0xf bank_mask:0xf
v_and_b32_dpp v58, v39, v7 row_newbcast:8 row_mask:0xf bank_mask:0xf
s_add_u32 m0, s79, 30144
s_mov_b32 s78, 118784
buffer_load_dwordx4 v4, s[60:63], s78 offen  lds
v_and_b32_dpp v59, v39, v8 row_newbcast:8 row_mask:0xf bank_mask:0xf
s_nop 0
s_nop 0
v_mfma_f32_16x16x32_bf16 v[72:75], v[56:59], v[248:251], v[72:75]
buffer_load_dwordx4 v[244:247], v1, s[44:47], s75 offen nt
s_add_u32 s75, s75, s72
s_and_b32 s75, s75, s73
v_and_b32_dpp v60, v39, v5 row_newbcast:12 row_mask:0xf bank_mask:0xf
v_and_b32_dpp v61, v39, v6 row_newbcast:12 row_mask:0xf bank_mask:0xf
v_and_b32_dpp v62, v39, v7 row_newbcast:12 row_mask:0xf bank_mask:0xf
v_and_b32_dpp v63, v39, v8 row_newbcast:12 row_mask:0xf bank_mask:0xf
s_nop 0
s_nop 0
buffer_load_dwordx4 v[248:251], v1, s[44:47], s75 offen nt
s_add_u32 s75, s75, s72
s_and_b32 s75, s75, s73
v_mfma_f32_16x16x32_bf16 v[72:75], v[60:63], v[252:255], v[72:75]
s_nop 7
v_cvt_pk_bf16_f32 v84, v72, v73
v_cvt_pk_bf16_f32 v85, v74, v75
s_add_u32 m0, s79, 31200
s_mov_b32 s78, 122880
buffer_load_dwordx4 v4, s[60:63], s78 offen  lds
ds_write_b64 v9, v[84:85] offset:2304
s_waitcnt lgkmcnt(0)
buffer_load_dwordx4 v[252:255], v1, s[44:47], s75 offen nt
s_add_u32 s75, s75, s72
s_and_b32 s75, s75, s73
s_add_u32 m0, s79, 32224
s_mov_b32 s78, 126976
buffer_load_dwordx4 v4, s[60:63], s78 offen  lds
s_waitcnt vmcnt(44)
v_mfma_f32_16x16x32_bf16 v[64:67], v[128:131], v[20:23], 0
buffer_load_dwordx4 v[128:131], v1, s[44:47], s75 offen nt
s_add_u32 s75, s75, s72
s_and_b32 s75, s75, s73
s_waitcnt vmcnt(44)
v_mfma_f32_16x16x32_bf16 v[64:67], v[132:135], v[24:27], v[64:67]
buffer_load_dwordx4 v[132:135], v1, s[44:47], s75 offen nt
s_add_u32 s75, s75, s72
s_and_b32 s75, s75, s73
s_waitcnt vmcnt(44)
v_mfma_f32_16x16x32_bf16 v[64:67], v[136:139], v[28:31], v[64:67]
buffer_load_dwordx4 v[136:139], v1, s[44:47], s75 offen nt
s_add_u32 s75, s75, s72
s_and_b32 s75, s75, s73
s_waitcnt vmcnt(44)
v_mfma_f32_16x16x32_bf16 v[64:67], v[140:143], v[32:35], v[64:67]
s_waitcnt vmcnt(43)
v_mfma_f32_16x16x32_bf16 v[68:71], v[144:147], v[20:23], 0
buffer_load_dwordx4 v[140:143], v1, s[44:47], s75 offen nt
s_add_u32 s75, s75, s72
s_and_b32 s75, s75, s73
s_waitcnt vmcnt(43)
v_mfma_f32_16x16x32_bf16 v[68:71], v[148:151], v[24:27], v[68:71]
s_waitcnt vmcnt(42)
v_mfma_f32_16x16x32_bf16 v[68:71], v[152:155], v[28:31], v[68:71]
buffer_load_dwordx4 v[144:147], v1, s[44:47], s75 offen nt
s_add_u32 s75, s75, s72
s_and_b32 s75, s75, s73
s_waitcnt vmcnt(42)
v_mfma_f32_16x16x32_bf16 v[68:71], v[156:159], v[32:35], v[68:71]
v_mov_b32_dpp v36, v64 quad_perm:[0,0,0,0] row_mask:0xf bank_mask:0xf
v_add_f32_dpp v36, v65, v36 quad_perm:[1,1,1,1] row_mask:0xf bank_mask:0xf
v_add_f32_dpp v36, v66, v36 quad_perm:[2,2,2,2] row_mask:0xf bank_mask:0xf
v_add_f32_dpp v36, v67, v36 quad_perm:[3,3,3,3] row_mask:0xf bank_mask:0xf
s_waitcnt vmcnt(41)
v_mfma_f32_16x16x32_bf16 v[64:67], v[160:163], v[20:23], 0
buffer_load_dwordx4 v[148:151], v1, s[44:47], s75 offen nt
s_add_u32 s75, s75, s72
s_and_b32 s75, s75, s73
s_waitcnt vmcnt(41)
v_mfma_f32_16x16x32_bf16 v[64:67], v[164:167], v[24:27], v[64:67]
s_waitcnt vmcnt(40)
v_mfma_f32_16x16x32_bf16 v[64:67], v[168:171], v[28:31], v[64:67]
buffer_load_dwordx4 v[152:155], v1, s[44:47], s75 offen nt
s_add_u32 s75, s75, s72
s_and_b32 s75, s75, s73
s_waitcnt vmcnt(40)
v_mfma_f32_16x16x32_bf16 v[64:67], v[172:175], v[32:35], v[64:67]
v_mov_b32_dpp v37, v68 quad_perm:[0,0,0,0] row_mask:0xf bank_mask:0xf
v_add_f32_dpp v37, v69, v37 quad_perm:[1,1,1,1] row_mask:0xf bank_mask:0xf
v_add_f32_dpp v37, v70, v37 quad_perm:[2,2,2,2] row_mask:0xf bank_mask:0xf
v_add_f32_dpp v37, v71, v37 quad_perm:[3,3,3,3] row_mask:0xf bank_mask:0xf
buffer_load_dwordx4 v[156:159], v1, s[44:47], s75 offen nt
s_add_u32 s75, s75, s72
s_and_b32 s75, s75, s73
s_waitcnt vmcnt(40)
v_mfma_f32_16x16x32_bf16 v[68:71], v[176:179], v[20:23], 0
s_waitcnt vmcnt(39)
v_mfma_f32_16x16x32_bf16 v[68:71], v[180:183], v[24:27], v[68:71]
s_waitcnt vmcnt(38)
v_mfma_f32_16x16x32_bf16 v[68:71], v[184:187], v[28:31], v[68:71]
buffer_load_dwordx4 v[160:163], v1, s[44:47], s75 offen nt
s_add_u32 s75, s75, s72
s_and_b32 s75, s75, s73
s_waitcnt vmcnt(38)
v_mfma_f32_16x16x32_bf16 v[68:71], v[188:191], v[32:35], v[68:71]
v_mov_b32_dpp v38, v64 quad_perm:[0,0,0,0] row_mask:0xf bank_mask:0xf
v_add_f32_dpp v38, v65, v38 quad_perm:[1,1,1,1] row_mask:0xf bank_mask:0xf
v_add_f32_dpp v38, v66, v38 quad_perm:[2,2,2,2] row_mask:0xf bank_mask:0xf
buffer_load_dwordx4 v[164:167], v1, s[44:47], s75 offen nt
s_add_u32 s75, s75, s72
s_and_b32 s75, s75, s73
v_add_f32_dpp v38, v67, v38 quad_perm:[3,3,3,3] row_mask:0xf bank_mask:0xf
s_nop 3
v_mov_b32_dpp v39, v68 quad_perm:[0,0,0,0] row_mask:0xf bank_mask:0xf
v_add_f32_dpp v39, v69, v39 quad_perm:[1,1,1,1] row_mask:0xf bank_mask:0xf
v_add_f32_dpp v39, v70, v39 quad_perm:[2,2,2,2] row_mask:0xf bank_mask:0xf
v_add_f32_dpp v39, v71, v39 quad_perm:[3,3,3,3] row_mask:0xf bank_mask:0xf
s_waitcnt vmcnt(10)
s_barrier
buffer_load_dwordx4 v[168:171], v1, s[44:47], s75 offen nt
s_add_u32 s75, s75, s72
s_and_b32 s75, s75, s73
ds_read_b128 v[84:87], v10 offset:2304
ds_read_b128 v[88:91], v10 offset:2368
ds_read_b128 v[92:95], v10 offset:2432
ds_read_b128 v[96:99], v10 offset:2496
ds_read_b128 v[80:83], v52 offset:64
ds_read_b64_tr_b16 v[100:101], v11 offset:0
ds_read_b64_tr_b16 v[102:103], v11 offset:1024
ds_read_b64_tr_b16 v[104:105], v11 offset:8320
ds_read_b64_tr_b16 v[106:107], v11 offset:9344
ds_read_b64_tr_b16 v[108:109], v11 offset:16640
ds_read_b64_tr_b16 v[110:111], v11 offset:17664
ds_read_b64_tr_b16 v[112:113], v11 offset:24960
ds_read_b64_tr_b16 v[114:115], v11 offset:25984
ds_read_b64_tr_b16 v[116:117], v11 offset:32
ds_read_b64_tr_b16 v[118:119], v11 offset:1056
s_waitcnt lgkmcnt(8)
v_mfma_f32_16x16x32_bf16 v[64:67], v[84:87], v[100:103], 0
ds_read_b64_tr_b16 v[120:121], v11 offset:8352
ds_read_b64_tr_b16 v[122:123], v11 offset:9376
ds_read_b64_tr_b16 v[124:125], v11 offset:16672
ds_read_b64_tr_b16 v[126:127], v11 offset:17696
v_max3_f32 v59, v80, v81, v82
v_max_f32 v59, v59, v83
v_sub_f32 v80, v80, v59
v_sub_f32 v81, v81, v59
v_sub_f32 v82, v82, v59
v_sub_f32 v83, v83, v59
s_waitcnt lgkmcnt(10)
v_mfma_f32_16x16x32_bf16 v[64:67], v[88:91], v[104:107], v[64:67]
ds_read_b64_tr_b16 v[100:101], v11 offset:24992
ds_read_b64_tr_b16 v[102:103], v11 offset:26016
v_exp_f32 v80, v80
v_exp_f32 v81, v81
v_exp_f32 v82, v82
v_exp_f32 v83, v83
s_waitcnt lgkmcnt(10)
v_mfma_f32_16x16x32_bf16 v[64:67], v[92:95], v[108:111], v[64:67]
ds_read_b64_tr_b16 v[104:105], v12 offset:0
ds_read_b64_tr_b16 v[106:107], v12 offset:1024
s_waitcnt lgkmcnt(10)
v_mfma_f32_16x16x32_bf16 v[64:67], v[96:99], v[112:115], v[64:67]
buffer_load_dwordx4 v[172:175], v1, s[44:47], s75 offen nt
s_add_u32 s75, s75, s72
s_and_b32 s75, s75, s73
ds_read_b64_tr_b16 v[108:109], v12 offset:8320
ds_read_b64_tr_b16 v[110:111], v12 offset:9344
s_waitcnt lgkmcnt(10)
v_mfma_f32_16x16x32_bf16 v[68:71], v[84:87], v[116:119], 0
ds_read_b64_tr_b16 v[112:113], v12 offset:16640
ds_read_b64_tr_b16 v[114:115], v12 offset:17664
s_waitcnt lgkmcnt(10)
v_mfma_f32_16x16x32_bf16 v[68:71], v[88:91], v[120:123], v[68:71]
ds_read_b64_tr_b16 v[116:117], v12 offset:24960
ds_read_b64_tr_b16 v[118:119], v12 offset:25984
s_waitcnt lgkmcnt(10)
v_mfma_f32_16x16x32_bf16 v[68:71], v[92:95], v[124:127], v[68:71]
ds_read_b64_tr_b16 v[120:121], v12 offset:32
ds_read_b64_tr_b16 v[122:123], v12 offset:1056
s_waitcnt lgkmcnt(10)
v_mfma_f32_16x16x32_bf16 v[68:71], v[96:99], v[100:103], v[68:71]
ds_read_b64_tr_b16 v[124:125], v12 offset:8352
ds_read_b64_tr_b16 v[126:127], v12 offset:9376
v_fmac_f32_dpp v76, v64, v80 quad_perm:[0,1,2,3] row_mask:0x1 bank_mask:0xf
v_fmac_f32_dpp v76, v65, v81 quad_perm:[0,1,2,3] row_mask:0x1 bank_mask:0xf
v_fmac_f32_dpp v76, v66, v82 quad_perm:[0,1,2,3] row_mask:0x1 bank_mask:0xf
v_fmac_f32_dpp v76, v67, v83 quad_perm:[0,1,2,3] row_mask:0x1 bank_mask:0xf
s_waitcnt lgkmcnt(10)
v_mfma_f32_16x16x32_bf16 v[64:67], v[84:87], v[104:107], 0
ds_read_b64_tr_b16 v[100:101], v12 offset:16672
ds_read_b64_tr_b16 v[102:103], v12 offset:17696
s_waitcnt lgkmcnt(10)
v_mfma_f32_16x16x32_bf16 v[64:67], v[88:91], v[108:111], v[64:67]
buffer_load_dwordx4 v[176:179], v1, s[44:47], s75 offen nt
s_add_u32 s75, s75, s72
s_and_b32 s75, s75, s73
ds_read_b64_tr_b16 v[104:105], v12 offset:24992
ds_read_b64_tr_b16 v[106:107], v12 offset:26016
s_waitcnt lgkmcnt(10)
v_mfma_f32_16x16x32_bf16 v[64:67], v[92:95], v[112:115], v[64:67]
ds_read_b64_tr_b16 v[108:109], v13 offset:0
ds_read_b64_tr_b16 v[110:111], v13 offset:1024
s_waitcnt lgkmcnt(10)
v_mfma_f32_16x16x32_bf16 v[64:67], v[96:99], v[116:119], v[64:67]
ds_read_b64_tr_b16 v[112:113], v13 offset:8320
ds_read_b64_tr_b16 v[114:115], v13 offset:9344
v_fmac_f32_dpp v77, v68, v80 quad_perm:[0,1,2,3] row_mask:0x1 bank_mask:0xf
v_fmac_f32_dpp v77, v69, v81 quad_perm:[0,1,2,3] row_mask:0x1 bank_mask:0xf
v_fmac_f32_dpp v77, v70, v82 quad_perm:[0,1,2,3] row_mask:0x1 bank_mask:0xf
v_fmac_f32_dpp v77, v71, v83 quad_perm:[0,1,2,3] row_mask:0x1 bank_mask:0xf
s_waitcnt lgkmcnt(10)
v_mfma_f32_16x16x32_bf16 v[68:71], v[84:87], v[120:123], 0
ds_read_b64_tr_b16 v[116:117], v13 offset:16640
ds_read_b64_tr_b16 v[118:119], v13 offset:17664
s_waitcnt lgkmcnt(10)
v_mfma_f32_16x16x32_bf16 v[68:71], v[88:91], v[124:127], v[68:71]
ds_read_b64_tr_b16 v[120:121], v13 offset:24960
ds_read_b64_tr_b16 v[122:123], v13 offset:25984
s_waitcnt lgkmcnt(10)
v_mfma_f32_16x16x32_bf16 v[68:71], v[92:95], v[100:103], v[68:71]
ds_read_b64_tr_b16 v[124:125], v13 offset:32
ds_read_b64_tr_b16 v[126:127], v13 offset:1056
s_waitcnt lgkmcnt(10)
v_mfma_f32_16x16x32_bf16 v[68:71], v[96:99], v[104:107], v[68:71]
buffer_load_dwordx4 v[180:183], v1, s[44:47], s75 offen nt
s_add_u32 s75, s75, s72
s_and_b32 s75, s75, s73
ds_read_b64_tr_b16 v[100:101], v13 offset:8352
ds_read_b64_tr_b16 v[102:103], v13 offset:9376
v_fmac_f32_dpp v78, v64, v80 quad_perm:[0,1,2,3] row_mask:0x1 bank_mask:0xf
v_fmac_f32_dpp v78, v65, v81 quad_perm:[0,1,2,3] row_mask:0x1 bank_mask:0xf
v_fmac_f32_dpp v78, v66, v82 quad_perm:[0,1,2,3] row_mask:0x1 bank_mask:0xf
v_fmac_f32_dpp v78, v67, v83 quad_perm:[0,1,2,3] row_mask:0x1 bank_mask:0xf
s_waitcnt lgkmcnt(10)
v_mfma_f32_16x16x32_bf16 v[64:67], v[84:87], v[108:111], 0
ds_read_b64_tr_b16 v[104:105], v13 offset:16672
ds_read_b64_tr_b16 v[106:107], v13 offset:17696
s_waitcnt lgkmcnt(10)
v_mfma_f32_16x16x32_bf16 v[64:67], v[88:91], v[112:115], v[64:67]
ds_read_b64_tr_b16 v[108:109], v13 offset:24992
ds_read_b64_tr_b16 v[110:111], v13 offset:26016
s_waitcnt lgkmcnt(10)
v_mfma_f32_16x16x32_bf16 v[64:67], v[92:95], v[116:119], v[64:67]
ds_read_b64_tr_b16 v[112:113], v14 offset:0
ds_read_b64_tr_b16 v[114:115], v14 offset:1024
s_waitcnt lgkmcnt(10)
v_mfma_f32_16x16x32_bf16 v[64:67], v[96:99], v[120:123], v[64:67]
ds_read_b64_tr_b16 v[116:117], v14 offset:8320
ds_read_b64_tr_b16 v[118:119], v14 offset:9344
v_fmac_f32_dpp v79, v68, v80 quad_perm:[0,1,2,3] row_mask:0x1 bank_mask:0xf
v_fmac_f32_dpp v79, v69, v81 quad_perm:[0,1,2,3] row_mask:0x1 bank_mask:0xf
v_fmac_f32_dpp v79, v70, v82 quad_perm:[0,1,2,3] row_mask:0x1 bank_mask:0xf
v_fmac_f32_dpp v79, v71, v83 quad_perm:[0,1,2,3] row_mask:0x1 bank_mask:0xf
s_waitcnt lgkmcnt(10)
v_mfma_f32_16x16x32_bf16 v[68:71], v[84:87], v[124:127], 0
buffer_load_dwordx4 v[184:187], v1, s[44:47], s75 offen nt
s_add_u32 s75, s75, s72
s_and_b32 s75, s75, s73
ds_read_b64_tr_b16 v[120:121], v14 offset:16640
ds_read_b64_tr_b16 v[122:123], v14 offset:17664
s_waitcnt lgkmcnt(10)
v_mfma_f32_16x16x32_bf16 v[68:71], v[88:91], v[100:103], v[68:71]
ds_read_b64_tr_b16 v[124:125], v14 offset:24960
ds_read_b64_tr_b16 v[126:127], v14 offset:25984
s_waitcnt lgkmcnt(10)
v_mfma_f32_16x16x32_bf16 v[68:71], v[92:95], v[104:107], v[68:71]
ds_read_b64_tr_b16 v[100:101], v14 offset:32
ds_read_b64_tr_b16 v[102:103], v14 offset:1056
s_waitcnt lgkmcnt(10)
v_mfma_f32_16x16x32_bf16 v[68:71], v[96:99], v[108:111], v[68:71]
ds_read_b64_tr_b16 v[104:105], v14 offset:8352
ds_read_b64_tr_b16 v[106:107], v14 offset:9376
v_fmac_f32_dpp v76, v64, v80 quad_perm:[0,1,2,3] row_mask:0x2 bank_mask:0xf
v_fmac_f32_dpp v76, v65, v81 quad_perm:[0,1,2,3] row_mask:0x2 bank_mask:0xf
v_fmac_f32_dpp v76, v66, v82 quad_perm:[0,1,2,3] row_mask:0x2 bank_mask:0xf
v_fmac_f32_dpp v76, v67, v83 quad_perm:[0,1,2,3] row_mask:0x2 bank_mask:0xf
s_waitcnt lgkmcnt(10)
v_mfma_f32_16x16x32_bf16 v[64:67], v[84:87], v[112:115], 0
ds_read_b64_tr_b16 v[108:109], v14 offset:16672
ds_read_b64_tr_b16 v[110:111], v14 offset:17696
s_waitcnt lgkmcnt(10)
v_mfma_f32_16x16x32_bf16 v[64:67], v[88:91], v[116:119], v[64:67]
ds_read_b64_tr_b16 v[112:113], v14 offset:24992
ds_read_b64_tr_b16 v[114:115], v14 offset:26016
s_waitcnt lgkmcnt(10)
v_mfma_f32_16x16x32_bf16 v[64:67], v[92:95], v[120:123], v[64:67]
buffer_load_dwordx4 v[188:191], v1, s[44:47], s75 offen nt
s_add_u32 s75, s75, s72
s_and_b32 s75, s75, s73
s_waitcnt lgkmcnt(8)
v_mfma_f32_16x16x32_bf16 v[64:67], v[96:99], v[124:127], v[64:67]
v_fmac_f32_dpp v77, v68, v80 quad_perm:[0,1,2,3] row_mask:0x2 bank_mask:0xf
v_fmac_f32_dpp v77, v69, v81 quad_perm:[0,1,2,3] row_mask:0x2 bank_mask:0xf
v_fmac_f32_dpp v77, v70, v82 quad_perm:[0,1,2,3] row_mask:0x2 bank_mask:0xf
v_fmac_f32_dpp v77, v71, v83 quad_perm:[0,1,2,3] row_mask:0x2 bank_mask:0xf
s_waitcnt lgkmcnt(6)
v_mfma_f32_16x16x32_bf16 v[68:71], v[84:87], v[100:103], 0
s_waitcnt lgkmcnt(4)
v_mfma_f32_16x16x32_bf16 v[68:71], v[88:91], v[104:107], v[68:71]
s_waitcnt lgkmcnt(2)
v_mfma_f32_16x16x32_bf16 v[68:71], v[92:95], v[108:111], v[68:71]
s_waitcnt lgkmcnt(0)
v_mfma_f32_16x16x32_bf16 v[68:71], v[96:99], v[112:115], v[68:71]
v_fmac_f32_dpp v78, v64, v80 quad_perm:[0,1,2,3] row_mask:0x2 bank_mask:0xf
v_fmac_f32_dpp v78, v65, v81 quad_perm:[0,1,2,3] row_mask:0x2 bank_mask:0xf
v_fmac_f32_dpp v78, v66, v82 quad_perm:[0,1,2,3] row_mask:0x2 bank_mask:0xf
v_fmac_f32_dpp v78, v67, v83 quad_perm:[0,1,2,3] row_mask:0x2 bank_mask:0xf
s_nop 3
v_fmac_f32_dpp v79, v68, v80 quad_perm:[0,1,2,3] row_mask:0x2 bank_mask:0xf
v_fmac_f32_dpp v79, v69, v81 quad_perm:[0,1,2,3] row_mask:0x2 bank_mask:0xf
v_fmac_f32_dpp v79, v70, v82 quad_perm:[0,1,2,3] row_mask:0x2 bank_mask:0xf
v_fmac_f32_dpp v79, v71, v83 quad_perm:[0,1,2,3] row_mask:0x2 bank_mask:0xf
s_nop 0
v_mfma_f32_16x16x32_bf16 v[64:67], v[192:195], v[20:23], 0
buffer_load_dwordx4 v[192:195], v2, s[48:51], s75 offen nt
s_add_u32 s75, s75, s72
s_and_b32 s75, s75, s73
s_add_u32 m0, s79, 0
s_mov_b32 s78, 0
buffer_load_dwordx4 v4, s[84:87], s78 offen  lds
s_nop 0
v_mfma_f32_16x16x32_bf16 v[64:67], v[196:199], v[24:27], v[64:67]
buffer_load_dwordx4 v[196:199], v2, s[48:51], s75 offen nt
s_add_u32 s75, s75, s72
s_and_b32 s75, s75, s73
s_nop 0
v_mfma_f32_16x16x32_bf16 v[64:67], v[200:203], v[28:31], v[64:67]
buffer_load_dwordx4 v[200:203], v2, s[48:51], s75 offen nt
s_add_u32 s75, s75, s72
s_and_b32 s75, s75, s73
s_add_u32 m0, s79, 1024
s_mov_b32 s78, 4096
buffer_load_dwordx4 v4, s[84:87], s78 offen  lds
s_nop 0
v_mfma_f32_16x16x32_bf16 v[64:67], v[204:207], v[32:35], v[64:67]
buffer_load_dwordx4 v[204:207], v2, s[48:51], s75 offen nt
s_add_u32 s75, s75, s72
s_and_b32 s75, s75, s73
s_nop 0
s_add_u32 m0, s79, 2080
s_mov_b32 s78, 8192
buffer_load_dwordx4 v4, s[84:87], s78 offen  lds
v_mfma_f32_16x16x32_bf16 v[68:71], v[208:211], v[20:23], 0
s_nop 0
buffer_load_dwordx4 v[208:211], v2, s[48:51], s75 offen nt
s_add_u32 s75, s75, s72
s_and_b32 s75, s75, s73
v_mfma_f32_16x16x32_bf16 v[68:71], v[212:215], v[24:27], v[68:71]
buffer_load_dwordx4 v[212:215], v2, s[48:51], s75 offen nt
s_add_u32 s75, s75, s72
s_and_b32 s75, s75, s73
s_nop 0
v_mfma_f32_16x16x32_bf16 v[68:71], v[216:219], v[28:31], v[68:71]
s_add_u32 m0, s79, 3104
s_mov_b32 s78, 12288
buffer_load_dwordx4 v4, s[84:87], s78 offen  lds
s_nop 0
v_mfma_f32_16x16x32_bf16 v[68:71], v[220:223], v[32:35], v[68:71]
buffer_load_dwordx4 v[216:219], v2, s[48:51], s75 offen nt
s_add_u32 s75, s75, s72
s_and_b32 s75, s75, s73
v_mov_b32_dpp v44, v64 quad_perm:[0,0,0,0] row_mask:0xf bank_mask:0xf
v_add_f32_dpp v44, v65, v44 quad_perm:[1,1,1,1] row_mask:0xf bank_mask:0xf
s_add_u32 m0, s79, 4160
s_mov_b32 s78, 16384
buffer_load_dwordx4 v4, s[84:87], s78 offen  lds
v_add_f32_dpp v44, v66, v44 quad_perm:[2,2,2,2] row_mask:0xf bank_mask:0xf
v_add_f32_dpp v44, v67, v44 quad_perm:[3,3,3,3] row_mask:0xf bank_mask:0xf
s_nop 0
v_mfma_f32_16x16x32_bf16 v[64:67], v[224:227], v[20:23], 0
buffer_load_dwordx4 v[220:223], v2, s[48:51], s75 offen nt
s_add_u32 s75, s75, s72
s_and_b32 s75, s75, s73
s_nop 0
v_mfma_f32_16x16x32_bf16 v[64:67], v[228:231], v[24:27], v[64:67]
s_add_u32 m0, s79, 5184
s_mov_b32 s78, 20480
buffer_load_dwordx4 v4, s[84:87], s78 offen  lds
s_nop 0
buffer_load_dwordx4 v[224:227], v2, s[48:51], s75 offen nt
s_add_u32 s75, s75, s72
s_and_b32 s75, s75, s73
v_mfma_f32_16x16x32_bf16 v[64:67], v[232:235], v[28:31], v[64:67]
buffer_load_dwordx4 v[228:231], v2, s[48:51], s75 offen nt
s_add_u32 s75, s75, s72
s_and_b32 s75, s75, s73
s_nop 0
v_mfma_f32_16x16x32_bf16 v[64:67], v[236:239], v[32:35], v[64:67]
s_add_u32 m0, s79, 6240
s_mov_b32 s78, 24576
buffer_load_dwordx4 v4, s[84:87], s78 offen  lds
v_mov_b32_dpp v45, v68 quad_perm:[0,0,0,0] row_mask:0xf bank_mask:0xf
v_add_f32_dpp v45, v69, v45 quad_perm:[1,1,1,1] row_mask:0xf bank_mask:0xf
v_add_f32_dpp v45, v70, v45 quad_perm:[2,2,2,2] row_mask:0xf bank_mask:0xf
buffer_load_dwordx4 v[232:235], v2, s[48:51], s75 offen nt
s_add_u32 s75, s75, s72
s_and_b32 s75, s75, s73
v_add_f32_dpp v45, v71, v45 quad_perm:[3,3,3,3] row_mask:0xf bank_mask:0xf
s_nop 0
v_mfma_f32_16x16x32_bf16 v[68:71], v[240:243], v[20:23], 0
s_add_u32 m0, s79, 7264
s_mov_b32 s78, 28672
buffer_load_dwordx4 v4, s[84:87], s78 offen  lds
s_nop 0
v_mfma_f32_16x16x32_bf16 v[68:71], v[244:247], v[24:27], v[68:71]
buffer_load_dwordx4 v[236:239], v2, s[48:51], s75 offen nt
s_add_u32 s75, s75, s72
s_and_b32 s75, s75, s73
s_nop 0
v_mfma_f32_16x16x32_bf16 v[68:71], v[248:251], v[28:31], v[68:71]
buffer_load_dwordx4 v[240:243], v2, s[48:51], s75 offen nt
s_add_u32 s75, s75, s72
s_and_b32 s75, s75, s73
s_nop 0
s_add_u32 m0, s79, 8320
s_mov_b32 s78, 32768
buffer_load_dwordx4 v4, s[84:87], s78 offen  lds
v_mfma_f32_16x16x32_bf16 v[68:71], v[252:255], v[32:35], v[68:71]
buffer_load_dwordx4 v[244:247], v2, s[48:51], s75 offen nt
s_add_u32 s75, s75, s72
s_and_b32 s75, s75, s73
v_mov_b32_dpp v46, v64 quad_perm:[0,0,0,0] row_mask:0xf bank_mask:0xf
v_add_f32_dpp v46, v65, v46 quad_perm:[1,1,1,1] row_mask:0xf bank_mask:0xf
v_add_f32_dpp v46, v66, v46 quad_perm:[2,2,2,2] row_mask:0xf bank_mask:0xf
v_add_f32_dpp v46, v67, v46 quad_perm:[3,3,3,3] row_mask:0xf bank_mask:0xf
s_nop 3
s_add_u32 m0, s79, 9344
s_mov_b32 s78, 36864
buffer_load_dwordx4 v4, s[84:87], s78 offen  lds
v_mov_b32_dpp v47, v68 quad_perm:[0,0,0,0] row_mask:0xf bank_mask:0xf
v_add_f32_dpp v47, v69, v47 quad_perm:[1,1,1,1] row_mask:0xf bank_mask:0xf
v_add_f32_dpp v47, v70, v47 quad_perm:[2,2,2,2] row_mask:0xf bank_mask:0xf
v_add_f32_dpp v47, v71, v47 quad_perm:[3,3,3,3] row_mask:0xf bank_mask:0xf
buffer_load_dwordx4 v[248:251], v2, s[48:51], s75 offen nt
s_add_u32 s75, s75, s72
s_and_b32 s75, s75, s73
buffer_load_dwordx4 v[252:255], v2, s[48:51], s75 offen nt
s_add_u32 s75, s75, s72
s_and_b32 s75, s75, s73
s_add_u32 m0, s79, 10400
s_mov_b32 s78, 40960
buffer_load_dwordx4 v4, s[84:87], s78 offen  lds
s_waitcnt vmcnt(42)
v_mfma_f32_16x16x32_bf16 v[64:67], v[128:131], v[20:23], 0
buffer_load_dwordx4 v[128:131], v2, s[48:51], s75 offen nt
s_add_u32 s75, s75, s72
s_and_b32 s75, s75, s73
s_waitcnt vmcnt(42)
v_mfma_f32_16x16x32_bf16 v[64:67], v[132:135], v[24:27], v[64:67]
s_waitcnt vmcnt(41)
s_add_u32 m0, s79, 11424
s_mov_b32 s78, 45056
buffer_load_dwordx4 v4, s[84:87], s78 offen  lds
v_mfma_f32_16x16x32_bf16 v[64:67], v[136:139], v[28:31], v[64:67]
s_waitcnt vmcnt(41)
v_mfma_f32_16x16x32_bf16 v[64:67], v[140:143], v[32:35], v[64:67]
s_waitcnt vmcnt(40)
v_mfma_f32_16x16x32_bf16 v[68:71], v[144:147], v[20:23], 0
buffer_load_dwordx4 v[132:135], v2, s[48:51], s75 offen nt
s_add_u32 s75, s75, s72
s_and_b32 s75, s75, s73
s_waitcnt vmcnt(40)
v_mfma_f32_16x16x32_bf16 v[68:71], v[148:151], v[24:27], v[68:71]
s_waitcnt vmcnt(39)
v_mfma_f32_16x16x32_bf16 v[68:71], v[152:155], v[28:31], v[68:71]
buffer_load_dwordx4 v[136:139], v2, s[48:51], s75 offen nt
s_add_u32 s75, s75, s72
s_and_b32 s75, s75, s73
s_waitcnt vmcnt(39)
v_mfma_f32_16x16x32_bf16 v[68:71], v[156:159], v[32:35], v[68:71]
v_mov_b32_dpp v48, v64 quad_perm:[0,0,0,0] row_mask:0xf bank_mask:0xf
v_add_f32_dpp v48, v65, v48 quad_perm:[1,1,1,1] row_mask:0xf bank_mask:0xf
v_add_f32_dpp v48, v66, v48 quad_perm:[2,2,2,2] row_mask:0xf bank_mask:0xf
v_add_f32_dpp v48, v67, v48 quad_perm:[3,3,3,3] row_mask:0xf bank_mask:0xf
s_add_u32 m0, s79, 12480
s_mov_b32 s78, 49152
buffer_load_dwordx4 v4, s[84:87], s78 offen  lds
s_waitcnt vmcnt(39)
v_mfma_f32_16x16x32_bf16 v[64:67], v[160:163], v[20:23], 0
s_waitcnt vmcnt(38)
v_mfma_f32_16x16x32_bf16 v[64:67], v[164:167], v[24:27], v[64:67]
s_waitcnt vmcnt(37)
buffer_load_dwordx4 v[140:143], v2, s[48:51], s75 offen nt
s_add_u32 s75, s75, s72
s_and_b32 s75, s75, s73
v_mfma_f32_16x16x32_bf16 v[64:67], v[168:171], v[28:31], v[64:67]
s_waitcnt vmcnt(37)
v_mfma_f32_16x16x32_bf16 v[64:67], v[172:175], v[32:35], v[64:67]
v_mov_b32_dpp v49, v68 quad_perm:[0,0,0,0] row_mask:0xf bank_mask:0xf
v_add_f32_dpp v49, v69, v49 quad_perm:[1,1,1,1] row_mask:0xf bank_mask:0xf
s_add_u32 m0, s79, 13504
s_mov_b32 s78, 53248
buffer_load_dwordx4 v4, s[84:87], s78 offen  lds
v_add_f32_dpp v49, v70, v49 quad_perm:[2,2,2,2] row_mask:0xf bank_mask:0xf
v_add_f32_dpp v49, v71, v49 quad_perm:[3,3,3,3] row_mask:0xf bank_mask:0xf
s_waitcnt vmcnt(37)
v_mfma_f32_16x16x32_bf16 v[68:71], v[176:179], v[20:23], 0
s_waitcnt vmcnt(36)
v_mfma_f32_16x16x32_bf16 v[68:71], v[180:183], v[24:27], v[68:71]
buffer_load_dwordx4 v[144:147], v2, s[48:51], s75 offen nt
s_add_u32 s75, s75, s72
s_and_b32 s75, s75, s73
s_waitcnt vmcnt(36)
v_mfma_f32_16x16x32_bf16 v[68:71], v[184:187], v[28:31], v[68:71]
s_waitcnt vmcnt(35)
v_mfma_f32_16x16x32_bf16 v[68:71], v[188:191], v[32:35], v[68:71]
buffer_load_dwordx4 v[148:151], v2, s[48:51], s75 offen nt
s_add_u32 s75, s75, s72
s_and_b32 s75, s75, s73
v_mov_b32_dpp v50, v64 quad_perm:[0,0,0,0] row_mask:0xf bank_mask:0xf
v_add_f32_dpp v50, v65, v50 quad_perm:[1,1,1,1] row_mask:0xf bank_mask:0xf
v_add_f32_dpp v50, v66, v50 quad_perm:[2,2,2,2] row_mask:0xf bank_mask:0xf
v_add_f32_dpp v50, v67, v50 quad_perm:[3,3,3,3] row_mask:0xf bank_mask:0xf
s_nop 3
v_mov_b32_dpp v51, v68 quad_perm:[0,0,0,0] row_mask:0xf bank_mask:0xf
v_add_f32_dpp v51, v69, v51 quad_perm:[1,1,1,1] row_mask:0xf bank_mask:0xf
v_add_f32_dpp v51, v70, v51 quad_perm:[2,2,2,2] row_mask:0xf bank_mask:0xf
v_add_f32_dpp v51, v71, v51 quad_perm:[3,3,3,3] row_mask:0xf bank_mask:0xf
v_cvt_pk_bf16_f32 v84, v36, v37
s_add_u32 m0, s79, 14560
s_mov_b32 s78, 57344
buffer_load_dwordx4 v4, s[84:87], s78 offen  lds
v_cvt_pk_bf16_f32 v85, v38, v39
v_cvt_pk_bf16_f32 v86, v40, v41
v_cvt_pk_bf16_f32 v87, v42, v43
v_cvt_pk_bf16_f32 v88, v44, v45
v_cvt_pk_bf16_f32 v89, v46, v47
v_cvt_pk_bf16_f32 v90, v48, v49
v_cvt_pk_bf16_f32 v91, v50, v51
v_lshlrev_b32 v36, 16, v84
v_and_b32 v37, s67, v84
v_lshlrev_b32 v38, 16, v85
v_and_b32 v39, s67, v85
buffer_load_dwordx4 v[152:155], v2, s[48:51], s75 offen nt
s_add_u32 s75, s75, s72
s_and_b32 s75, s75, s73
v_lshlrev_b32 v40, 16, v86
v_and_b32 v41, s67, v86
v_lshlrev_b32 v42, 16, v87
v_and_b32 v43, s67, v87
v_lshlrev_b32 v44, 16, v88
v_and_b32 v45, s67, v88
v_lshlrev_b32 v46, 16, v89
v_and_b32 v47, s67, v89
v_lshlrev_b32 v48, 16, v90
v_and_b32 v49, s67, v90
v_lshlrev_b32 v50, 16, v91
v_and_b32 v51, s67, v91
s_add_u32 m0, s79, 15584
s_mov_b32 s78, 61440
buffer_load_dwordx4 v4, s[84:87], s78 offen  lds
v_mul_f32 v36, s65, v36
v_mul_f32 v37, s65, v37
v_mul_f32 v38, s65, v38
v_mul_f32 v39, s65, v39
v_mul_f32 v40, s65, v40
v_mul_f32 v41, s65, v41
v_mul_f32 v42, s65, v42
v_mul_f32 v43, s65, v43
v_mul_f32 v44, s65, v44
v_mul_f32 v45, s65, v45
buffer_load_dwordx4 v[156:159], v2, s[48:51], s75 offen nt
s_add_u32 s75, s75, s72
s_and_b32 s75, s75, s73
v_mul_f32 v46, s65, v46
v_mul_f32 v47, s65, v47
v_mul_f32 v48, s65, v48
v_mul_f32 v49, s65, v49
v_mul_f32 v50, s65, v50
v_mul_f32 v51, s65, v51
v_cvt_pk_bf16_f32 v84, v36, v37
v_cvt_pk_bf16_f32 v85, v38, v39
v_cvt_pk_bf16_f32 v86, v40, v41
v_cvt_pk_bf16_f32 v87, v42, v43
v_cvt_pk_bf16_f32 v88, v44, v45
s_add_u32 m0, s79, 16640
s_mov_b32 s78, 65536
buffer_load_dwordx4 v4, s[84:87], s78 offen  lds
v_cvt_pk_bf16_f32 v89, v46, v47
v_cvt_pk_bf16_f32 v90, v48, v49
v_cvt_pk_bf16_f32 v91, v50, v51
v_lshlrev_b32 v36, 16, v84
v_and_b32 v37, s67, v84
v_lshlrev_b32 v38, 16, v85
v_and_b32 v39, s67, v85
v_lshlrev_b32 v40, 16, v86
v_and_b32 v41, s67, v86
v_lshlrev_b32 v42, 16, v87
v_and_b32 v43, s67, v87
buffer_load_dwordx4 v[160:163], v2, s[48:51], s75 offen nt
s_add_u32 s75, s75, s72
s_and_b32 s75, s75, s73
v_lshlrev_b32 v44, 16, v88
v_and_b32 v45, s67, v88
v_lshlrev_b32 v46, 16, v89
v_and_b32 v47, s67, v89
v_lshlrev_b32 v48, 16, v90
v_and_b32 v49, s67, v90
v_lshlrev_b32 v50, 16, v91
v_and_b32 v51, s67, v91
v_max3_f32 v84, v36, v37, v38
v_max3_f32 v84, v84, v39, v40
v_max3_f32 v84, v84, v41, v42
buffer_load_dwordx4 v[164:167], v2, s[48:51], s75 offen nt
s_add_u32 s75, s75, s72
s_and_b32 s75, s75, s73
v_max3_f32 v84, v84, v43, v44
v_max3_f32 v84, v84, v45, v46
v_max3_f32 v84, v84, v47, v48
v_max3_f32 v84, v84, v49, v50
v_max_f32 v84, v84, v51
s_nop 1
v_max_f32_dpp v84, v84, v84 row_ror:4 row_mask:0xf bank_mask:0xf
s_nop 1
v_max_f32_dpp v84, v84, v84 row_ror:8 row_mask:0xf bank_mask:0xf
s_nop 1
v_max_f32_dpp v84, v84, v84 row_bcast:15 row_mask:0xa bank_mask:0xf
s_add_u32 m0, s79, 17664
s_mov_b32 s78, 69632
buffer_load_dwordx4 v4, s[84:87], s78 offen  lds
s_nop 1
v_max_f32_dpp v84, v84, v84 row_bcast:31 row_mask:0xc bank_mask:0xf
s_nop 1
v_readlane_b32 s80, v84, 63
v_mov_b32 v86, s66
s_nop 1
v_mul_f32 v86, s80, v86
v_fma_f32 v36, v36, s66, -v86
v_fma_f32 v37, v37, s66, -v86
v_fma_f32 v38, v38, s66, -v86
v_fma_f32 v39, v39, s66, -v86
buffer_load_dwordx4 v[168:171], v2, s[48:51], s75 offen nt
s_add_u32 s75, s75, s72
s_and_b32 s75, s75, s73
v_fma_f32 v40, v40, s66, -v86
v_fma_f32 v41, v41, s66, -v86
v_fma_f32 v42, v42, s66, -v86
v_fma_f32 v43, v43, s66, -v86
v_fma_f32 v44, v44, s66, -v86
v_fma_f32 v45, v45, s66, -v86
v_fma_f32 v46, v46, s66, -v86
v_fma_f32 v47, v47, s66, -v86
v_fma_f32 v48, v48, s66, -v86
v_fma_f32 v49, v49, s66, -v86
s_add_u32 m0, s79, 18720
s_mov_b32 s78, 73728
buffer_load_dwordx4 v4, s[84:87], s78 offen  lds
v_fma_f32 v50, v50, s66, -v86
v_fma_f32 v51, v51, s66, -v86
v_exp_f32 v36, v36
v_exp_f32 v37, v37
v_exp_f32 v38, v38
v_exp_f32 v39, v39
v_exp_f32 v40, v40
buffer_load_dwordx4 v[172:175], v2, s[48:51], s75 offen nt
s_add_u32 s75, s75, s72
s_and_b32 s75, s75, s73
v_exp_f32 v41, v41
v_exp_f32 v42, v42
v_exp_f32 v43, v43
v_exp_f32 v44, v44
v_exp_f32 v45, v45
buffer_load_dwordx4 v[176:179], v2, s[48:51], s75 offen nt
s_add_u32 s75, s75, s72
s_and_b32 s75, s75, s73
v_exp_f32 v46, v46
v_exp_f32 v47, v47
v_exp_f32 v48, v48
v_exp_f32 v49, v49
v_exp_f32 v50, v50
v_exp_f32 v51, v51
s_add_u32 m0, s79, 19744
s_mov_b32 s78, 77824
buffer_load_dwordx4 v4, s[84:87], s78 offen  lds
v_add_f32 v87, v36, v37
v_add_f32 v87, v87, v38
v_add_f32 v87, v87, v39
v_add_f32 v87, v87, v40
v_add_f32 v87, v87, v41
v_add_f32 v87, v87, v42
v_add_f32 v87, v87, v43
v_add_f32 v87, v87, v44
v_add_f32 v87, v87, v45
v_add_f32 v87, v87, v46
buffer_load_dwordx4 v[180:183], v2, s[48:51], s75 offen nt
s_add_u32 s75, s75, s72
s_and_b32 s75, s75, s73
v_add_f32 v87, v87, v47
v_add_f32 v87, v87, v48
v_add_f32 v87, v87, v49
v_add_f32 v87, v87, v50
v_add_f32 v87, v87, v51
v_cvt_pk_bf16_f32 v36, v36, v36
v_cvt_pk_bf16_f32 v37, v37, v37
v_cvt_pk_bf16_f32 v38, v38, v38
v_cvt_pk_bf16_f32 v39, v39, v39
v_cvt_pk_bf16_f32 v40, v40, v40
v_cvt_pk_bf16_f32 v41, v41, v41
s_add_u32 m0, s79, 20800
s_mov_b32 s78, 81920
buffer_load_dwordx4 v4, s[84:87], s78 offen  lds
v_cvt_pk_bf16_f32 v42, v42, v42
v_cvt_pk_bf16_f32 v43, v43, v43
v_cvt_pk_bf16_f32 v44, v44, v44
v_cvt_pk_bf16_f32 v45, v45, v45
v_cvt_pk_bf16_f32 v46, v46, v46
v_cvt_pk_bf16_f32 v47, v47, v47
v_cvt_pk_bf16_f32 v48, v48, v48
v_cvt_pk_bf16_f32 v49, v49, v49
v_cvt_pk_bf16_f32 v50, v50, v50
v_cvt_pk_bf16_f32 v51, v51, v51
s_nop 1
v_add_f32_dpp v87, v87, v87 row_ror:4 row_mask:0xf bank_mask:0xf
buffer_load_dwordx4 v[184:187], v2, s[48:51], s75 offen nt
s_add_u32 s75, s75, s72
s_and_b32 s75, s75, s73
s_nop 1
v_add_f32_dpp v87, v87, v87 row_ror:8 row_mask:0xf bank_mask:0xf
s_nop 1
v_add_f32_dpp v87, v87, v87 row_bcast:15 row_mask:0xa bank_mask:0xf
s_nop 1
v_add_f32_dpp v87, v87, v87 row_bcast:31 row_mask:0xc bank_mask:0xf
v_mov_b32 v84, s64
s_mov_b32 exec_lo, 0
s_mov_b32 exec_hi, 0x80000000
ds_write2_b32 v84, v86, v87 offset0:0 offset1:4
s_mov_b64 exec, -1
buffer_load_dwordx4 v[188:191], v2, s[48:51], s75 offen nt
s_add_u32 s75, s75, s72
s_and_b32 s75, s75, s73
v_mov_b32 v72, 0
v_mov_b32 v73, 0
v_mov_b32 v74, 0
v_mov_b32 v75, 0
s_add_u32 m0, s79, 21824
s_mov_b32 s78, 86016
buffer_load_dwordx4 v4, s[84:87], s78 offen  lds
v_and_b32_dpp v56, v40, v5 row_newbcast:0 row_mask:0xf bank_mask:0xf
v_and_b32_dpp v57, v40, v6 row_newbcast:0 row_mask:0xf bank_mask:0xf
v_and_b32_dpp v58, v40, v7 row_newbcast:0 row_mask:0xf bank_mask:0xf
v_and_b32_dpp v59, v40, v8 row_newbcast:0 row_mask:0xf bank_mask:0xf
s_nop 0
s_waitcnt vmcnt(53)
v_mfma_f32_16x16x32_bf16 v[72:75], v[56:59], v[192:195], v[72:75]
buffer_load_dwordx4 v[192:195], v2, s[48:51], s75 offen nt
s_add_u32 s75, s75, s72
s_and_b32 s75, s75, s73
s_add_u32 m0, s79, 22880
s_mov_b32 s78, 90112
buffer_load_dwordx4 v4, s[84:87], s78 offen  lds
v_and_b32_dpp v60, v40, v5 row_newbcast:4 row_mask:0xf bank_mask:0xf
v_and_b32_dpp v61, v40, v6 row_newbcast:4 row_mask:0xf bank_mask:0xf
v_and_b32_dpp v62, v40, v7 row_newbcast:4 row_mask:0xf bank_mask:0xf
v_and_b32_dpp v63, v40, v8 row_newbcast:4 row_mask:0xf bank_mask:0xf
s_nop 0
s_waitcnt vmcnt(53)
v_mfma_f32_16x16x32_bf16 v[72:75], v[60:63], v[196:199], v[72:75]
buffer_load_dwordx4 v[196:199], v2, s[48:51], s75 offen nt
s_add_u32 s75, s75, s72
s_and_b32 s75, s75, s73
v_and_b32_dpp v56, v40, v5 row_newbcast:8 row_mask:0xf bank_mask:0xf
v_and_b32_dpp v57, v40, v6 row_newbcast:8 row_mask:0xf bank_mask:0xf
v_and_b32_dpp v58, v40, v7 row_newbcast:8 row_mask:0xf bank_mask:0xf
v_and_b32_dpp v59, v40, v8 row_newbcast:8 row_mask:0xf bank_mask:0xf
s_nop 0
s_waitcnt vmcnt(53)
v_mfma_f32_16x16x32_bf16 v[72:75], v[56:59], v[200:203], v[72:75]
buffer_load_dwordx4 v[200:203], v2, s[48:51], s75 offen nt
s_add_u32 s75, s75, s72
s_and_b32 s75, s75, s73
s_add_u32 m0, s79, 23904
s_mov_b32 s78, 94208
buffer_load_dwordx4 v4, s[84:87], s78 offen  lds
v_and_b32_dpp v60, v40, v5 row_newbcast:12 row_mask:0xf bank_mask:0xf
v_and_b32_dpp v61, v40, v6 row_newbcast:12 row_mask:0xf bank_mask:0xf
v_and_b32_dpp v62, v40, v7 row_newbcast:12 row_mask:0xf bank_mask:0xf
v_and_b32_dpp v63, v40, v8 row_newbcast:12 row_mask:0xf bank_mask:0xf
s_nop 0
s_waitcnt vmcnt(53)
v_mfma_f32_16x16x32_bf16 v[72:75], v[60:63], v[204:207], v[72:75]
buffer_load_dwordx4 v[204:207], v2, s[48:51], s75 offen nt
s_add_u32 s75, s75, s72
s_and_b32 s75, s75, s73
s_add_u32 m0, s79, 24960
s_mov_b32 s78, 98304
buffer_load_dwordx4 v4, s[84:87], s78 offen  lds
v_and_b32_dpp v56, v41, v5 row_newbcast:0 row_mask:0xf bank_mask:0xf
v_and_b32_dpp v57, v41, v6 row_newbcast:0 row_mask:0xf bank_mask:0xf
v_and_b32_dpp v58, v41, v7 row_newbcast:0 row_mask:0xf bank_mask:0xf
v_and_b32_dpp v59, v41, v8 row_newbcast:0 row_mask:0xf bank_mask:0xf
s_nop 0
s_waitcnt vmcnt(53)
v_mfma_f32_16x16x32_bf16 v[72:75], v[56:59], v[208:211], v[72:75]
buffer_load_dwordx4 v[208:211], v2, s[48:51], s75 offen nt
s_add_u32 s75, s75, s72
s_and_b32 s75, s75, s73
v_and_b32_dpp v60, v41, v5 row_newbcast:4 row_mask:0xf bank_mask:0xf
v_and_b32_dpp v61, v41, v6 row_newbcast:4 row_mask:0xf bank_mask:0xf
v_and_b32_dpp v62, v41, v7 row_newbcast:4 row_mask:0xf bank_mask:0xf
v_and_b32_dpp v63, v41, v8 row_newbcast:4 row_mask:0xf bank_mask:0xf
s_nop 0
s_waitcnt vmcnt(53)
v_mfma_f32_16x16x32_bf16 v[72:75], v[60:63], v[212:215], v[72:75]
buffer_load_dwordx4 v[212:215], v2, s[48:51], s75 offen nt
s_add_u32 s75, s75, s72
s_and_b32 s75, s75, s73
s_add_u32 m0, s79, 25984
s_mov_b32 s78, 102400
buffer_load_dwordx4 v4, s[84:87], s78 offen  lds
v_and_b32_dpp v56, v41, v5 row_newbcast:8 row_mask:0xf bank_mask:0xf
v_and_b32_dpp v57, v41, v6 row_newbcast:8 row_mask:0xf bank_mask:0xf
v_and_b32_dpp v58, v41, v7 row_newbcast:8 row_mask:0xf bank_mask:0xf
v_and_b32_dpp v59, v41, v8 row_newbcast:8 row_mask:0xf bank_mask:0xf
s_nop 0
s_waitcnt vmcnt(53)
v_mfma_f32_16x16x32_bf16 v[72:75], v[56:59], v[216:219], v[72:75]
buffer_load_dwordx4 v[216:219], v2, s[48:51], s75 offen nt
s_add_u32 s75, s75, s72
s_and_b32 s75, s75, s73
v_and_b32_dpp v60, v41, v5 row_newbcast:12 row_mask:0xf bank_mask:0xf
v_and_b32_dpp v61, v41, v6 row_newbcast:12 row_mask:0xf bank_mask:0xf
v_and_b32_dpp v62, v41, v7 row_newbcast:12 row_mask:0xf bank_mask:0xf
v_and_b32_dpp v63, v41, v8 row_newbcast:12 row_mask:0xf bank_mask:0xf
s_nop 0
s_waitcnt vmcnt(52)
v_mfma_f32_16x16x32_bf16 v[72:75], v[60:63], v[220:223], v[72:75]
buffer_load_dwordx4 v[220:223], v2, s[48:51], s75 offen nt
s_add_u32 s75, s75, s72
s_and_b32 s75, s75, s73
s_add_u32 m0, s79, 27040
s_mov_b32 s78, 106496
buffer_load_dwordx4 v4, s[84:87], s78 offen  lds
v_and_b32_dpp v56, v42, v5 row_newbcast:0 row_mask:0xf bank_mask:0xf
v_and_b32_dpp v57, v42, v6 row_newbcast:0 row_mask:0xf bank_mask:0xf
v_and_b32_dpp v58, v42, v7 row_newbcast:0 row_mask:0xf bank_mask:0xf
v_and_b32_dpp v59, v42, v8 row_newbcast:0 row_mask:0xf bank_mask:0xf
s_nop 0
s_waitcnt vmcnt(52)
v_mfma_f32_16x16x32_bf16 v[72:75], v[56:59], v[224:227], v[72:75]
buffer_load_dwordx4 v[224:227], v2, s[48:51], s75 offen nt
s_add_u32 s75, s75, s72
s_and_b32 s75, s75, s73
s_add_u32 m0, s79, 28064
s_mov_b32 s78, 110592
buffer_load_dwordx4 v4, s[84:87], s78 offen  lds
v_and_b32_dpp v60, v42, v5 row_newbcast:4 row_mask:0xf bank_mask:0xf
v_and_b32_dpp v61, v42, v6 row_newbcast:4 row_mask:0xf bank_mask:0xf
v_and_b32_dpp v62, v42, v7 row_newbcast:4 row_mask:0xf bank_mask:0xf
v_and_b32_dpp v63, v42, v8 row_newbcast:4 row_mask:0xf bank_mask:0xf
s_nop 0
s_waitcnt vmcnt(53)
v_mfma_f32_16x16x32_bf16 v[72:75], v[60:63], v[228:231], v[72:75]
buffer_load_dwordx4 v[228:231], v2, s[48:51], s75 offen nt
s_add_u32 s75, s75, s72
s_and_b32 s75, s75, s73
v_and_b32_dpp v56, v42, v5 row_newbcast:8 row_mask:0xf bank_mask:0xf
v_and_b32_dpp v57, v42, v6 row_newbcast:8 row_mask:0xf bank_mask:0xf
v_and_b32_dpp v58, v42, v7 row_newbcast:8 row_mask:0xf bank_mask:0xf
v_and_b32_dpp v59, v42, v8 row_newbcast:8 row_mask:0xf bank_mask:0xf
s_nop 0
s_waitcnt vmcnt(52)
v_mfma_f32_16x16x32_bf16 v[72:75], v[56:59], v[232:235], v[72:75]
buffer_load_dwordx4 v[232:235], v2, s[48:51], s75 offen nt
s_add_u32 s75, s75, s72
s_and_b32 s75, s75, s73
s_add_u32 m0, s79, 29120
s_mov_b32 s78, 114688
buffer_load_dwordx4 v4, s[84:87], s78 offen  lds
v_and_b32_dpp v60, v42, v5 row_newbcast:12 row_mask:0xf bank_mask:0xf
v_and_b32_dpp v61, v42, v6 row_newbcast:12 row_mask:0xf bank_mask:0xf
v_and_b32_dpp v62, v42, v7 row_newbcast:12 row_mask:0xf bank_mask:0xf
v_and_b32_dpp v63, v42, v8 row_newbcast:12 row_mask:0xf bank_mask:0xf
s_nop 0
s_waitcnt vmcnt(52)
v_mfma_f32_16x16x32_bf16 v[72:75], v[60:63], v[236:239], v[72:75]
buffer_load_dwordx4 v[236:239], v2, s[48:51], s75 offen nt
s_add_u32 s75, s75, s72
s_and_b32 s75, s75, s73
v_and_b32_dpp v56, v43, v5 row_newbcast:0 row_mask:0xf bank_mask:0xf
v_and_b32_dpp v57, v43, v6 row_newbcast:0 row_mask:0xf bank_mask:0xf
v_and_b32_dpp v58, v43, v7 row_newbcast:0 row_mask:0xf bank_mask:0xf
v_and_b32_dpp v59, v43, v8 row_newbcast:0 row_mask:0xf bank_mask:0xf
s_add_u32 m0, s79, 30144
s_mov_b32 s78, 118784
buffer_load_dwordx4 v4, s[84:87], s78 offen  lds
s_nop 0
s_waitcnt vmcnt(53)
v_mfma_f32_16x16x32_bf16 v[72:75], v[56:59], v[240:243], v[72:75]
v_and_b32_dpp v60, v43, v5 row_newbcast:4 row_mask:0xf bank_mask:0xf
buffer_load_dwordx4 v[240:243], v2, s[48:51], s75 offen nt
s_add_u32 s75, s75, s72
s_and_b32 s75, s75, s73
v_and_b32_dpp v61, v43, v6 row_newbcast:4 row_mask:0xf bank_mask:0xf
v_and_b32_dpp v62, v43, v7 row_newbcast:4 row_mask:0xf bank_mask:0xf
v_and_b32_dpp v63, v43, v8 row_newbcast:4 row_mask:0xf bank_mask:0xf
s_nop 0
s_waitcnt vmcnt(52)
v_mfma_f32_16x16x32_bf16 v[72:75], v[60:63], v[244:247], v[72:75]
buffer_load_dwordx4 v[244:247], v2, s[48:51], s75 offen nt
s_add_u32 s75, s75, s72
s_and_b32 s75, s75, s73
v_and_b32_dpp v56, v43, v5 row_newbcast:8 row_mask:0xf bank_mask:0xf
v_and_b32_dpp v57, v43, v6 row_newbcast:8 row_mask:0xf bank_mask:0xf
v_and_b32_dpp v58, v43, v7 row_newbcast:8 row_mask:0xf bank_mask:0xf
v_and_b32_dpp v59, v43, v8 row_newbcast:8 row_mask:0xf bank_mask:0xf
s_add_u32 m0, s79, 31200
s_mov_b32 s78, 122880
buffer_load_dwordx4 v4, s[84:87], s78 offen  lds
s_nop 0
s_waitcnt vmcnt(52)
v_mfma_f32_16x16x32_bf16 v[72:75], v[56:59], v[248:251], v[72:75]
v_and_b32_dpp v60, v43, v5 row_newbcast:12 row_mask:0xf bank_mask:0xf
buffer_load_dwordx4 v[248:251], v2, s[48:51], s75 offen nt
s_add_u32 s75, s75, s72
s_and_b32 s75, s75, s73
v_and_b32_dpp v61, v43, v6 row_newbcast:12 row_mask:0xf bank_mask:0xf
v_and_b32_dpp v62, v43, v7 row_newbcast:12 row_mask:0xf bank_mask:0xf
v_and_b32_dpp v63, v43, v8 row_newbcast:12 row_mask:0xf bank_mask:0xf
s_nop 0
s_waitcnt vmcnt(52)
v_mfma_f32_16x16x32_bf16 v[72:75], v[60:63], v[252:255], v[72:75]
buffer_load_dwordx4 v[252:255], v2, s[48:51], s75 offen nt
s_add_u32 s75, s75, s72
s_and_b32 s75, s75, s73
v_mov_b32 v84, 138368
ds_write_b32 v84, v84
s_add_u32 m0, s79, 32224
s_mov_b32 s78, 126976
buffer_load_dwordx4 v4, s[84:87], s78 offen  lds
v_and_b32_dpp v56, v36, v5 row_newbcast:0 row_mask:0xf bank_mask:0xf
v_and_b32_dpp v57, v36, v6 row_newbcast:0 row_mask:0xf bank_mask:0xf
v_and_b32_dpp v58, v36, v7 row_newbcast:0 row_mask:0xf bank_mask:0xf
v_and_b32_dpp v59, v36, v8 row_newbcast:0 row_mask:0xf bank_mask:0xf
s_nop 0
s_waitcnt vmcnt(52)
v_mfma_f32_16x16x32_bf16 v[72:75], v[56:59], v[128:131], v[72:75]
buffer_load_dwordx4 v[128:131], v2, s[48:51], s75 offen nt
s_add_u32 s75, s75, s72
s_and_b32 s75, s75, s73
v_and_b32_dpp v60, v36, v5 row_newbcast:4 row_mask:0xf bank_mask:0xf
v_and_b32_dpp v61, v36, v6 row_newbcast:4 row_mask:0xf bank_mask:0xf
v_and_b32_dpp v62, v36, v7 row_newbcast:4 row_mask:0xf bank_mask:0xf
v_and_b32_dpp v63, v36, v8 row_newbcast:4 row_mask:0xf bank_mask:0xf
s_nop 0
s_waitcnt vmcnt(51)
v_mfma_f32_16x16x32_bf16 v[72:75], v[60:63], v[132:135], v[72:75]
buffer_load_dwordx4 v[132:135], v2, s[48:51], s75 offen nt
s_add_u32 s75, s75, s72
s_and_b32 s75, s75, s73
v_and_b32_dpp v56, v36, v5 row_newbcast:8 row_mask:0xf bank_mask:0xf
v_and_b32_dpp v57, v36, v6 row_newbcast:8 row_mask:0xf bank_mask:0xf
v_and_b32_dpp v58, v36, v7 row_newbcast:8 row_mask:0xf bank_mask:0xf
v_and_b32_dpp v59, v36, v8 row_newbcast:8 row_mask:0xf bank_mask:0xf
s_nop 0
s_waitcnt vmcnt(51)
v_mfma_f32_16x16x32_bf16 v[72:75], v[56:59], v[136:139], v[72:75]
buffer_load_dwordx4 v[136:139], v2, s[48:51], s75 offen nt
s_add_u32 s75, s75, s72
s_and_b32 s75, s75, s73
v_and_b32_dpp v60, v36, v5 row_newbcast:12 row_mask:0xf bank_mask:0xf
v_and_b32_dpp v61, v36, v6 row_newbcast:12 row_mask:0xf bank_mask:0xf
v_and_b32_dpp v62, v36, v7 row_newbcast:12 row_mask:0xf bank_mask:0xf
v_and_b32_dpp v63, v36, v8 row_newbcast:12 row_mask:0xf bank_mask:0xf
s_nop 0
s_waitcnt vmcnt(50)
v_mfma_f32_16x16x32_bf16 v[72:75], v[60:63], v[140:143], v[72:75]
buffer_load_dwordx4 v[140:143], v2, s[48:51], s75 offen nt
s_add_u32 s75, s75, s72
s_and_b32 s75, s75, s73
v_and_b32_dpp v56, v37, v5 row_newbcast:0 row_mask:0xf bank_mask:0xf
v_and_b32_dpp v57, v37, v6 row_newbcast:0 row_mask:0xf bank_mask:0xf
v_and_b32_dpp v58, v37, v7 row_newbcast:0 row_mask:0xf bank_mask:0xf
v_and_b32_dpp v59, v37, v8 row_newbcast:0 row_mask:0xf bank_mask:0xf
s_nop 0
s_waitcnt vmcnt(49)
v_mfma_f32_16x16x32_bf16 v[72:75], v[56:59], v[144:147], v[72:75]
buffer_load_dwordx4 v[144:147], v2, s[48:51], s75 offen nt
s_add_u32 s75, s75, s72
s_and_b32 s75, s75, s73
v_and_b32_dpp v60, v37, v5 row_newbcast:4 row_mask:0xf bank_mask:0xf
v_and_b32_dpp v61, v37, v6 row_newbcast:4 row_mask:0xf bank_mask:0xf
v_and_b32_dpp v62, v37, v7 row_newbcast:4 row_mask:0xf bank_mask:0xf
v_and_b32_dpp v63, v37, v8 row_newbcast:4 row_mask:0xf bank_mask:0xf
s_nop 0
s_waitcnt vmcnt(49)
v_mfma_f32_16x16x32_bf16 v[72:75], v[60:63], v[148:151], v[72:75]
buffer_load_dwordx4 v[148:151], v2, s[48:51], s75 offen nt
s_add_u32 s75, s75, s72
s_and_b32 s75, s75, s73
v_and_b32_dpp v56, v37, v5 row_newbcast:8 row_mask:0xf bank_mask:0xf
v_and_b32_dpp v57, v37, v6 row_newbcast:8 row_mask:0xf bank_mask:0xf
v_and_b32_dpp v58, v37, v7 row_newbcast:8 row_mask:0xf bank_mask:0xf
v_and_b32_dpp v59, v37, v8 row_newbcast:8 row_mask:0xf bank_mask:0xf
s_nop 0
s_waitcnt vmcnt(48)
v_mfma_f32_16x16x32_bf16 v[72:75], v[56:59], v[152:155], v[72:75]
buffer_load_dwordx4 v[152:155], v2, s[48:51], s75 offen nt
s_add_u32 s75, s75, s72
s_and_b32 s75, s75, s73
v_and_b32_dpp v60, v37, v5 row_newbcast:12 row_mask:0xf bank_mask:0xf
v_and_b32_dpp v61, v37, v6 row_newbcast:12 row_mask:0xf bank_mask:0xf
v_and_b32_dpp v62, v37, v7 row_newbcast:12 row_mask:0xf bank_mask:0xf
v_and_b32_dpp v63, v37, v8 row_newbcast:12 row_mask:0xf bank_mask:0xf
s_nop 0
s_waitcnt vmcnt(47)
v_mfma_f32_16x16x32_bf16 v[72:75], v[60:63], v[156:159], v[72:75]
buffer_load_dwordx4 v[156:159], v2, s[48:51], s75 offen nt
s_add_u32 s75, s75, s72
s_and_b32 s75, s75, s73
v_and_b32_dpp v56, v38, v5 row_newbcast:0 row_mask:0xf bank_mask:0xf
v_and_b32_dpp v57, v38, v6 row_newbcast:0 row_mask:0xf bank_mask:0xf
v_and_b32_dpp v58, v38, v7 row_newbcast:0 row_mask:0xf bank_mask:0xf
v_and_b32_dpp v59, v38, v8 row_newbcast:0 row_mask:0xf bank_mask:0xf
s_nop 0
s_waitcnt vmcnt(46)
v_mfma_f32_16x16x32_bf16 v[72:75], v[56:59], v[160:163], v[72:75]
buffer_load_dwordx4 v[160:163], v2, s[48:51], s75 offen nt
s_add_u32 s75, s75, s72
s_and_b32 s75, s75, s73
v_and_b32_dpp v60, v38, v5 row_newbcast:4 row_mask:0xf bank_mask:0xf
v_and_b32_dpp v61, v38, v6 row_newbcast:4 row_mask:0xf bank_mask:0xf
v_and_b32_dpp v62, v38, v7 row_newbcast:4 row_mask:0xf bank_mask:0xf
v_and_b32_dpp v63, v38, v8 row_newbcast:4 row_mask:0xf bank_mask:0xf
s_nop 0
s_waitcnt vmcnt(46)
v_mfma_f32_16x16x32_bf16 v[72:75], v[60:63], v[164:167], v[72:75]
buffer_load_dwordx4 v[164:167], v2, s[48:51], s75 offen nt
s_add_u32 s75, s75, s72
s_and_b32 s75, s75, s73
v_and_b32_dpp v56, v38, v5 row_newbcast:8 row_mask:0xf bank_mask:0xf
v_and_b32_dpp v57, v38, v6 row_newbcast:8 row_mask:0xf bank_mask:0xf
v_and_b32_dpp v58, v38, v7 row_newbcast:8 row_mask:0xf bank_mask:0xf
v_and_b32_dpp v59, v38, v8 row_newbcast:8 row_mask:0xf bank_mask:0xf
s_nop 0
s_waitcnt vmcnt(45)
v_mfma_f32_16x16x32_bf16 v[72:75], v[56:59], v[168:171], v[72:75]
buffer_load_dwordx4 v[168:171], v2, s[48:51], s75 offen nt
s_add_u32 s75, s75, s72
s_and_b32 s75, s75, s73
v_and_b32_dpp v60, v38, v5 row_newbcast:12 row_mask:0xf bank_mask:0xf
v_and_b32_dpp v61, v38, v6 row_newbcast:12 row_mask:0xf bank_mask:0xf
v_and_b32_dpp v62, v38, v7 row_newbcast:12 row_mask:0xf bank_mask:0xf
v_and_b32_dpp v63, v38, v8 row_newbcast:12 row_mask:0xf bank_mask:0xf
s_nop 0
s_waitcnt vmcnt(44)
v_mfma_f32_16x16x32_bf16 v[72:75], v[60:63], v[172:175], v[72:75]
buffer_load_dwordx4 v[172:175], v2, s[48:51], s75 offen nt
s_add_u32 s75, s75, s72
s_and_b32 s75, s75, s73
v_and_b32_dpp v56, v39, v5 row_newbcast:0 row_mask:0xf bank_mask:0xf
v_and_b32_dpp v57, v39, v6 row_newbcast:0 row_mask:0xf bank_mask:0xf
v_and_b32_dpp v58, v39, v7 row_newbcast:0 row_mask:0xf bank_mask:0xf
v_and_b32_dpp v59, v39, v8 row_newbcast:0 row_mask:0xf bank_mask:0xf
s_nop 0
s_waitcnt vmcnt(44)
v_mfma_f32_16x16x32_bf16 v[72:75], v[56:59], v[176:179], v[72:75]
buffer_load_dwordx4 v[176:179], v2, s[48:51], s75 offen nt
s_add_u32 s75, s75, s72
s_and_b32 s75, s75, s73
v_and_b32_dpp v60, v39, v5 row_newbcast:4 row_mask:0xf bank_mask:0xf
v_and_b32_dpp v61, v39, v6 row_newbcast:4 row_mask:0xf bank_mask:0xf
v_and_b32_dpp v62, v39, v7 row_newbcast:4 row_mask:0xf bank_mask:0xf
v_and_b32_dpp v63, v39, v8 row_newbcast:4 row_mask:0xf bank_mask:0xf
s_nop 0
s_waitcnt vmcnt(43)
v_mfma_f32_16x16x32_bf16 v[72:75], v[60:63], v[180:183], v[72:75]
buffer_load_dwordx4 v[180:183], v2, s[48:51], s75 offen nt
s_add_u32 s75, s75, s72
s_and_b32 s75, s75, s73
v_and_b32_dpp v56, v39, v5 row_newbcast:8 row_mask:0xf bank_mask:0xf
v_and_b32_dpp v57, v39, v6 row_newbcast:8 row_mask:0xf bank_mask:0xf
v_and_b32_dpp v58, v39, v7 row_newbcast:8 row_mask:0xf bank_mask:0xf
v_and_b32_dpp v59, v39, v8 row_newbcast:8 row_mask:0xf bank_mask:0xf
s_nop 0
s_waitcnt vmcnt(42)
v_mfma_f32_16x16x32_bf16 v[72:75], v[56:59], v[184:187], v[72:75]
buffer_load_dwordx4 v[184:187], v2, s[48:51], s75 offen nt
s_add_u32 s75, s75, s72
s_and_b32 s75, s75, s73
v_and_b32_dpp v60, v39, v5 row_newbcast:12 row_mask:0xf bank_mask:0xf
v_and_b32_dpp v61, v39, v6 row_newbcast:12 row_mask:0xf bank_mask:0xf
v_and_b32_dpp v62, v39, v7 row_newbcast:12 row_mask:0xf bank_mask:0xf
v_and_b32_dpp v63, v39, v8 row_newbcast:12 row_mask:0xf bank_mask:0xf
s_nop 0
s_waitcnt vmcnt(42)
v_mfma_f32_16x16x32_bf16 v[72:75], v[60:63], v[188:191], v[72:75]
buffer_load_dwordx4 v[188:191], v2, s[48:51], s75 offen nt
s_add_u32 s75, s75, s72
s_and_b32 s75, s75, s73
v_and_b32_dpp v56, v44, v5 row_newbcast:0 row_mask:0xf bank_mask:0xf
v_and_b32_dpp v57, v44, v6 row_newbcast:0 row_mask:0xf bank_mask:0xf
v_and_b32_dpp v58, v44, v7 row_newbcast:0 row_mask:0xf bank_mask:0xf
v_and_b32_dpp v59, v44, v8 row_newbcast:0 row_mask:0xf bank_mask:0xf
s_nop 0
s_waitcnt vmcnt(41)
v_mfma_f32_16x16x32_bf16 v[72:75], v[56:59], v[192:195], v[72:75]
v_and_b32_dpp v60, v44, v5 row_newbcast:4 row_mask:0xf bank_mask:0xf
v_and_b32_dpp v61, v44, v6 row_newbcast:4 row_mask:0xf bank_mask:0xf
v_and_b32_dpp v62, v44, v7 row_newbcast:4 row_mask:0xf bank_mask:0xf
v_and_b32_dpp v63, v44, v8 row_newbcast:4 row_mask:0xf bank_mask:0xf
s_nop 0
s_waitcnt vmcnt(39)
v_mfma_f32_16x16x32_bf16 v[72:75], v[60:63], v[196:199], v[72:75]
v_and_b32_dpp v56, v44, v5 row_newbcast:8 row_mask:0xf bank_mask:0xf
v_and_b32_dpp v57, v44, v6 row_newbcast:8 row_mask:0xf bank_mask:0xf
v_and_b32_dpp v58, v44, v7 row_newbcast:8 row_mask:0xf bank_mask:0xf
v_and_b32_dpp v59, v44, v8 row_newbcast:8 row_mask:0xf bank_mask:0xf
s_nop 0
s_waitcnt vmcnt(38)
v_mfma_f32_16x16x32_bf16 v[72:75], v[56:59], v[200:203], v[72:75]
v_and_b32_dpp v60, v44, v5 row_newbcast:12 row_mask:0xf bank_mask:0xf
v_and_b32_dpp v61, v44, v6 row_newbcast:12 row_mask:0xf bank_mask:0xf
v_and_b32_dpp v62, v44, v7 row_newbcast:12 row_mask:0xf bank_mask:0xf
v_and_b32_dpp v63, v44, v8 row_newbcast:12 row_mask:0xf bank_mask:0xf
s_nop 0
s_waitcnt vmcnt(36)
v_mfma_f32_16x16x32_bf16 v[72:75], v[60:63], v[204:207], v[72:75]
v_and_b32_dpp v56, v45, v5 row_newbcast:0 row_mask:0xf bank_mask:0xf
v_and_b32_dpp v57, v45, v6 row_newbcast:0 row_mask:0xf bank_mask:0xf
v_and_b32_dpp v58, v45, v7 row_newbcast:0 row_mask:0xf bank_mask:0xf
v_and_b32_dpp v59, v45, v8 row_newbcast:0 row_mask:0xf bank_mask:0xf
s_nop 0
s_waitcnt vmcnt(34)
v_mfma_f32_16x16x32_bf16 v[72:75], v[56:59], v[208:211], v[72:75]
v_and_b32_dpp v60, v45, v5 row_newbcast:4 row_mask:0xf bank_mask:0xf
v_and_b32_dpp v61, v45, v6 row_newbcast:4 row_mask:0xf bank_mask:0xf
v_and_b32_dpp v62, v45, v7 row_newbcast:4 row_mask:0xf bank_mask:0xf
v_and_b32_dpp v63, v45, v8 row_newbcast:4 row_mask:0xf bank_mask:0xf
s_nop 0
s_waitcnt vmcnt(33)
v_mfma_f32_16x16x32_bf16 v[72:75], v[60:63], v[212:215], v[72:75]
v_and_b32_dpp v56, v45, v5 row_newbcast:8 row_mask:0xf bank_mask:0xf
v_and_b32_dpp v57, v45, v6 row_newbcast:8 row_mask:0xf bank_mask:0xf
v_and_b32_dpp v58, v45, v7 row_newbcast:8 row_mask:0xf bank_mask:0xf
v_and_b32_dpp v59, v45, v8 row_newbcast:8 row_mask:0xf bank_mask:0xf
s_nop 0
s_waitcnt vmcnt(31)
v_mfma_f32_16x16x32_bf16 v[72:75], v[56:59], v[216:219], v[72:75]
v_and_b32_dpp v60, v45, v5 row_newbcast:12 row_mask:0xf bank_mask:0xf
v_and_b32_dpp v61, v45, v6 row_newbcast:12 row_mask:0xf bank_mask:0xf
v_and_b32_dpp v62, v45, v7 row_newbcast:12 row_mask:0xf bank_mask:0xf
v_and_b32_dpp v63, v45, v8 row_newbcast:12 row_mask:0xf bank_mask:0xf
s_nop 0
s_waitcnt vmcnt(30)
v_mfma_f32_16x16x32_bf16 v[72:75], v[60:63], v[220:223], v[72:75]
v_and_b32_dpp v56, v46, v5 row_newbcast:0 row_mask:0xf bank_mask:0xf
v_and_b32_dpp v57, v46, v6 row_newbcast:0 row_mask:0xf bank_mask:0xf
v_and_b32_dpp v58, v46, v7 row_newbcast:0 row_mask:0xf bank_mask:0xf
v_and_b32_dpp v59, v46, v8 row_newbcast:0 row_mask:0xf bank_mask:0xf
s_nop 0
s_waitcnt vmcnt(28)
v_mfma_f32_16x16x32_bf16 v[72:75], v[56:59], v[224:227], v[72:75]
v_and_b32_dpp v60, v46, v5 row_newbcast:4 row_mask:0xf bank_mask:0xf
v_and_b32_dpp v61, v46, v6 row_newbcast:4 row_mask:0xf bank_mask:0xf
v_and_b32_dpp v62, v46, v7 row_newbcast:4 row_mask:0xf bank_mask:0xf
v_and_b32_dpp v63, v46, v8 row_newbcast:4 row_mask:0xf bank_mask:0xf
s_nop 0
s_waitcnt vmcnt(26)
v_mfma_f32_16x16x32_bf16 v[72:75], v[60:63], v[228:231], v[72:75]
v_and_b32_dpp v56, v46, v5 row_newbcast:8 row_mask:0xf bank_mask:0xf
v_and_b32_dpp v57, v46, v6 row_newbcast:8 row_mask:0xf bank_mask:0xf
v_and_b32_dpp v58, v46, v7 row_newbcast:8 row_mask:0xf bank_mask:0xf
v_and_b32_dpp v59, v46, v8 row_newbcast:8 row_mask:0xf bank_mask:0xf
s_nop 0
s_waitcnt vmcnt(25)
v_mfma_f32_16x16x32_bf16 v[72:75], v[56:59], v[232:235], v[72:75]
v_and_b32_dpp v60, v46, v5 row_newbcast:12 row_mask:0xf bank_mask:0xf
v_and_b32_dpp v61, v46, v6 row_newbcast:12 row_mask:0xf bank_mask:0xf
v_and_b32_dpp v62, v46, v7 row_newbcast:12 row_mask:0xf bank_mask:0xf
v_and_b32_dpp v63, v46, v8 row_newbcast:12 row_mask:0xf bank_mask:0xf
s_nop 0
s_waitcnt vmcnt(23)
v_mfma_f32_16x16x32_bf16 v[72:75], v[60:63], v[236:239], v[72:75]
v_and_b32_dpp v56, v47, v5 row_newbcast:0 row_mask:0xf bank_mask:0xf
v_and_b32_dpp v57, v47, v6 row_newbcast:0 row_mask:0xf bank_mask:0xf
v_and_b32_dpp v58, v47, v7 row_newbcast:0 row_mask:0xf bank_mask:0xf
v_and_b32_dpp v59, v47, v8 row_newbcast:0 row_mask:0xf bank_mask:0xf
s_nop 0
s_waitcnt vmcnt(21)
v_mfma_f32_16x16x32_bf16 v[72:75], v[56:59], v[240:243], v[72:75]
v_and_b32_dpp v60, v47, v5 row_newbcast:4 row_mask:0xf bank_mask:0xf
v_and_b32_dpp v61, v47, v6 row_newbcast:4 row_mask:0xf bank_mask:0xf
v_and_b32_dpp v62, v47, v7 row_newbcast:4 row_mask:0xf bank_mask:0xf
v_and_b32_dpp v63, v47, v8 row_newbcast:4 row_mask:0xf bank_mask:0xf
s_nop 0
s_waitcnt vmcnt(20)
v_mfma_f32_16x16x32_bf16 v[72:75], v[60:63], v[244:247], v[72:75]
v_and_b32_dpp v56, v47, v5 row_newbcast:8 row_mask:0xf bank_mask:0xf
v_and_b32_dpp v57, v47, v6 row_newbcast:8 row_mask:0xf bank_mask:0xf
v_and_b32_dpp v58, v47, v7 row_newbcast:8 row_mask:0xf bank_mask:0xf
v_and_b32_dpp v59, v47, v8 row_newbcast:8 row_mask:0xf bank_mask:0xf
s_nop 0
s_waitcnt vmcnt(18)
v_mfma_f32_16x16x32_bf16 v[72:75], v[56:59], v[248:251], v[72:75]
v_and_b32_dpp v60, v47, v5 row_newbcast:12 row_mask:0xf bank_mask:0xf
v_and_b32_dpp v61, v47, v6 row_newbcast:12 row_mask:0xf bank_mask:0xf
v_and_b32_dpp v62, v47, v7 row_newbcast:12 row_mask:0xf bank_mask:0xf
v_and_b32_dpp v63, v47, v8 row_newbcast:12 row_mask:0xf bank_mask:0xf
s_nop 0
s_waitcnt vmcnt(17)
v_mfma_f32_16x16x32_bf16 v[72:75], v[60:63], v[252:255], v[72:75]
ds_read_b128 v[24:27], v52 offset:144
ds_read_b64 v[22:23], v52 offset:160
v_add_u32 v20, 0x20000, v54
s_mov_b64 s[4:5], -1
s_mov_b64 s[6:7], -1
s_mov_b64 s[22:23], 1
s_add_u32 s24, s30, 622592
s_addc_u32 s25, s31, 0
s_cmp_eq_u32 s88, 0
s_cselect_b32 s26, 8, 0
s_mov_b32 s27, 0x20000
s_waitcnt lgkmcnt(0)
v_not_b32 v28, v24
v_not_b32 v32, v24
s_waitcnt vmcnt(16)
v_and_b32_dpp v56, v48, v5 row_newbcast:0 row_mask:0xf bank_mask:0xf
v_and_b32_dpp v57, v48, v6 row_newbcast:0 row_mask:0xf bank_mask:0xf
v_and_b32_dpp v58, v48, v7 row_newbcast:0 row_mask:0xf bank_mask:0xf
v_and_b32_dpp v59, v48, v8 row_newbcast:0 row_mask:0xf bank_mask:0xf
ds_read_b64_tr_b16 v[100:101], v11 offset:0
ds_read_b64_tr_b16 v[102:103], v11 offset:1024
ds_read_b64_tr_b16 v[104:105], v11 offset:8320
ds_read_b64_tr_b16 v[106:107], v11 offset:9344
ds_read_b64_tr_b16 v[108:109], v11 offset:16640
ds_read_b64_tr_b16 v[110:111], v11 offset:17664
s_waitcnt vmcnt(15)
v_mfma_f32_16x16x32_bf16 v[72:75], v[56:59], v[128:131], v[72:75]
v_and_b32_dpp v60, v48, v5 row_newbcast:4 row_mask:0xf bank_mask:0xf
v_and_b32_dpp v61, v48, v6 row_newbcast:4 row_mask:0xf bank_mask:0xf
v_and_b32_dpp v62, v48, v7 row_newbcast:4 row_mask:0xf bank_mask:0xf
v_and_b32_dpp v63, v48, v8 row_newbcast:4 row_mask:0xf bank_mask:0xf
ds_read_b64_tr_b16 v[112:113], v11 offset:24960
ds_read_b64_tr_b16 v[114:115], v11 offset:25984
ds_read_b64_tr_b16 v[116:117], v11 offset:32
ds_read_b64_tr_b16 v[118:119], v11 offset:1056
ds_read_b64_tr_b16 v[120:121], v11 offset:8352
ds_read_b64_tr_b16 v[122:123], v11 offset:9376
s_waitcnt vmcnt(14)
v_mfma_f32_16x16x32_bf16 v[72:75], v[60:63], v[132:135], v[72:75]
v_and_b32_dpp v56, v48, v5 row_newbcast:8 row_mask:0xf bank_mask:0xf
v_and_b32_dpp v57, v48, v6 row_newbcast:8 row_mask:0xf bank_mask:0xf
v_and_b32_dpp v58, v48, v7 row_newbcast:8 row_mask:0xf bank_mask:0xf
v_and_b32_dpp v59, v48, v8 row_newbcast:8 row_mask:0xf bank_mask:0xf
ds_read_b64_tr_b16 v[124:125], v11 offset:16672
ds_read_b64_tr_b16 v[126:127], v11 offset:17696
ds_read_b64_tr_b16 v[192:193], v11 offset:24992
ds_read_b64_tr_b16 v[194:195], v11 offset:26016
ds_read_b64_tr_b16 v[196:197], v12 offset:0
ds_read_b64_tr_b16 v[198:199], v12 offset:1024
s_waitcnt vmcnt(13)
v_mfma_f32_16x16x32_bf16 v[72:75], v[56:59], v[136:139], v[72:75]
v_and_b32_dpp v60, v48, v5 row_newbcast:12 row_mask:0xf bank_mask:0xf
v_and_b32_dpp v61, v48, v6 row_newbcast:12 row_mask:0xf bank_mask:0xf
v_and_b32_dpp v62, v48, v7 row_newbcast:12 row_mask:0xf bank_mask:0xf
v_and_b32_dpp v63, v48, v8 row_newbcast:12 row_mask:0xf bank_mask:0xf
ds_read_b64_tr_b16 v[200:201], v12 offset:8320
ds_read_b64_tr_b16 v[202:203], v12 offset:9344
ds_read_b64_tr_b16 v[204:205], v12 offset:16640
ds_read_b64_tr_b16 v[206:207], v12 offset:17664
ds_read_b64_tr_b16 v[208:209], v12 offset:24960
ds_read_b64_tr_b16 v[210:211], v12 offset:25984
s_waitcnt vmcnt(12)
v_mfma_f32_16x16x32_bf16 v[72:75], v[60:63], v[140:143], v[72:75]
v_and_b32_dpp v56, v49, v5 row_newbcast:0 row_mask:0xf bank_mask:0xf
v_and_b32_dpp v57, v49, v6 row_newbcast:0 row_mask:0xf bank_mask:0xf
v_and_b32_dpp v58, v49, v7 row_newbcast:0 row_mask:0xf bank_mask:0xf
v_and_b32_dpp v59, v49, v8 row_newbcast:0 row_mask:0xf bank_mask:0xf
ds_read_b64_tr_b16 v[212:213], v12 offset:32
ds_read_b64_tr_b16 v[214:215], v12 offset:1056
ds_read_b64_tr_b16 v[216:217], v12 offset:8352
ds_read_b64_tr_b16 v[218:219], v12 offset:9376
ds_read_b64_tr_b16 v[220:221], v12 offset:16672
ds_read_b64_tr_b16 v[222:223], v12 offset:17696
s_waitcnt vmcnt(11)
v_mfma_f32_16x16x32_bf16 v[72:75], v[56:59], v[144:147], v[72:75]
v_and_b32_dpp v60, v49, v5 row_newbcast:4 row_mask:0xf bank_mask:0xf
v_and_b32_dpp v61, v49, v6 row_newbcast:4 row_mask:0xf bank_mask:0xf
v_and_b32_dpp v62, v49, v7 row_newbcast:4 row_mask:0xf bank_mask:0xf
v_and_b32_dpp v63, v49, v8 row_newbcast:4 row_mask:0xf bank_mask:0xf
ds_read_b64_tr_b16 v[224:225], v12 offset:24992
ds_read_b64_tr_b16 v[226:227], v12 offset:26016
ds_read_b64_tr_b16 v[228:229], v13 offset:0
ds_read_b64_tr_b16 v[230:231], v13 offset:1024
ds_read_b64_tr_b16 v[232:233], v13 offset:8320
ds_read_b64_tr_b16 v[234:235], v13 offset:9344
s_waitcnt vmcnt(10)
v_mfma_f32_16x16x32_bf16 v[72:75], v[60:63], v[148:151], v[72:75]
v_and_b32_dpp v56, v49, v5 row_newbcast:8 row_mask:0xf bank_mask:0xf
v_and_b32_dpp v57, v49, v6 row_newbcast:8 row_mask:0xf bank_mask:0xf
v_and_b32_dpp v58, v49, v7 row_newbcast:8 row_mask:0xf bank_mask:0xf
v_and_b32_dpp v59, v49, v8 row_newbcast:8 row_mask:0xf bank_mask:0xf
ds_read_b64_tr_b16 v[236:237], v13 offset:16640
ds_read_b64_tr_b16 v[238:239], v13 offset:17664
ds_read_b64_tr_b16 v[240:241], v13 offset:24960
ds_read_b64_tr_b16 v[242:243], v13 offset:25984
ds_read_b64_tr_b16 v[244:245], v13 offset:32
ds_read_b64_tr_b16 v[246:247], v13 offset:1056
s_waitcnt vmcnt(9)
v_mfma_f32_16x16x32_bf16 v[72:75], v[56:59], v[152:155], v[72:75]
v_and_b32_dpp v60, v49, v5 row_newbcast:12 row_mask:0xf bank_mask:0xf
v_and_b32_dpp v61, v49, v6 row_newbcast:12 row_mask:0xf bank_mask:0xf
v_and_b32_dpp v62, v49, v7 row_newbcast:12 row_mask:0xf bank_mask:0xf
v_and_b32_dpp v63, v49, v8 row_newbcast:12 row_mask:0xf bank_mask:0xf
ds_read_b64_tr_b16 v[248:249], v13 offset:8352
ds_read_b64_tr_b16 v[250:251], v13 offset:9376
ds_read_b64_tr_b16 v[252:253], v13 offset:16672
ds_read_b64_tr_b16 v[254:255], v13 offset:17696
ds_read_b64_tr_b16 v[128:129], v13 offset:24992
ds_read_b64_tr_b16 v[130:131], v13 offset:26016
s_waitcnt vmcnt(8)
v_mfma_f32_16x16x32_bf16 v[72:75], v[60:63], v[156:159], v[72:75]
v_and_b32_dpp v56, v50, v5 row_newbcast:0 row_mask:0xf bank_mask:0xf
v_and_b32_dpp v57, v50, v6 row_newbcast:0 row_mask:0xf bank_mask:0xf
v_and_b32_dpp v58, v50, v7 row_newbcast:0 row_mask:0xf bank_mask:0xf
v_and_b32_dpp v59, v50, v8 row_newbcast:0 row_mask:0xf bank_mask:0xf
ds_read_b64_tr_b16 v[132:133], v14 offset:0
ds_read_b64_tr_b16 v[134:135], v14 offset:1024
ds_read_b64_tr_b16 v[136:137], v14 offset:8320
ds_read_b64_tr_b16 v[138:139], v14 offset:9344
ds_read_b64_tr_b16 v[140:141], v14 offset:16640
ds_read_b64_tr_b16 v[142:143], v14 offset:17664
s_waitcnt vmcnt(7)
v_mfma_f32_16x16x32_bf16 v[72:75], v[56:59], v[160:163], v[72:75]
v_and_b32_dpp v60, v50, v5 row_newbcast:4 row_mask:0xf bank_mask:0xf
v_and_b32_dpp v61, v50, v6 row_newbcast:4 row_mask:0xf bank_mask:0xf
v_and_b32_dpp v62, v50, v7 row_newbcast:4 row_mask:0xf bank_mask:0xf
v_and_b32_dpp v63, v50, v8 row_newbcast:4 row_mask:0xf bank_mask:0xf
ds_read_b64_tr_b16 v[144:145], v14 offset:24960
ds_read_b64_tr_b16 v[146:147], v14 offset:25984
ds_read_b64_tr_b16 v[148:149], v14 offset:32
ds_read_b64_tr_b16 v[150:151], v14 offset:1056
ds_read_b64_tr_b16 v[152:153], v14 offset:8352
ds_read_b64_tr_b16 v[154:155], v14 offset:9376
s_waitcnt vmcnt(6)
v_mfma_f32_16x16x32_bf16 v[72:75], v[60:63], v[164:167], v[72:75]
v_and_b32_dpp v56, v50, v5 row_newbcast:8 row_mask:0xf bank_mask:0xf
v_and_b32_dpp v57, v50, v6 row_newbcast:8 row_mask:0xf bank_mask:0xf
v_and_b32_dpp v58, v50, v7 row_newbcast:8 row_mask:0xf bank_mask:0xf
v_and_b32_dpp v59, v50, v8 row_newbcast:8 row_mask:0xf bank_mask:0xf
ds_read_b64_tr_b16 v[156:157], v14 offset:16672
ds_read_b64_tr_b16 v[158:159], v14 offset:17696
ds_read_b64_tr_b16 v[160:161], v14 offset:24992
ds_read_b64_tr_b16 v[162:163], v14 offset:26016
s_waitcnt vmcnt(5)
v_mfma_f32_16x16x32_bf16 v[72:75], v[56:59], v[168:171], v[72:75]
v_and_b32_dpp v60, v50, v5 row_newbcast:12 row_mask:0xf bank_mask:0xf
v_and_b32_dpp v61, v50, v6 row_newbcast:12 row_mask:0xf bank_mask:0xf
v_and_b32_dpp v62, v50, v7 row_newbcast:12 row_mask:0xf bank_mask:0xf
v_and_b32_dpp v63, v50, v8 row_newbcast:12 row_mask:0xf bank_mask:0xf
s_nop 0
s_waitcnt vmcnt(4)
v_mfma_f32_16x16x32_bf16 v[72:75], v[60:63], v[172:175], v[72:75]
v_and_b32_dpp v56, v51, v5 row_newbcast:0 row_mask:0xf bank_mask:0xf
v_and_b32_dpp v57, v51, v6 row_newbcast:0 row_mask:0xf bank_mask:0xf
v_and_b32_dpp v58, v51, v7 row_newbcast:0 row_mask:0xf bank_mask:0xf
v_and_b32_dpp v59, v51, v8 row_newbcast:0 row_mask:0xf bank_mask:0xf
s_nop 0
s_waitcnt vmcnt(3)
v_mfma_f32_16x16x32_bf16 v[72:75], v[56:59], v[176:179], v[72:75]
v_and_b32_dpp v60, v51, v5 row_newbcast:4 row_mask:0xf bank_mask:0xf
v_and_b32_dpp v61, v51, v6 row_newbcast:4 row_mask:0xf bank_mask:0xf
v_and_b32_dpp v62, v51, v7 row_newbcast:4 row_mask:0xf bank_mask:0xf
v_and_b32_dpp v63, v51, v8 row_newbcast:4 row_mask:0xf bank_mask:0xf
s_nop 0
s_waitcnt vmcnt(2)
v_mfma_f32_16x16x32_bf16 v[72:75], v[60:63], v[180:183], v[72:75]
v_and_b32_dpp v56, v51, v5 row_newbcast:8 row_mask:0xf bank_mask:0xf
v_and_b32_dpp v57, v51, v6 row_newbcast:8 row_mask:0xf bank_mask:0xf
v_and_b32_dpp v58, v51, v7 row_newbcast:8 row_mask:0xf bank_mask:0xf
v_and_b32_dpp v59, v51, v8 row_newbcast:8 row_mask:0xf bank_mask:0xf
s_nop 0
s_waitcnt vmcnt(1)
v_mfma_f32_16x16x32_bf16 v[72:75], v[56:59], v[184:187], v[72:75]
v_and_b32_dpp v60, v51, v5 row_newbcast:12 row_mask:0xf bank_mask:0xf
v_and_b32_dpp v61, v51, v6 row_newbcast:12 row_mask:0xf bank_mask:0xf
v_and_b32_dpp v62, v51, v7 row_newbcast:12 row_mask:0xf bank_mask:0xf
v_and_b32_dpp v63, v51, v8 row_newbcast:12 row_mask:0xf bank_mask:0xf
s_nop 0
s_waitcnt vmcnt(0)
v_mfma_f32_16x16x32_bf16 v[72:75], v[60:63], v[188:191], v[72:75]
s_nop 7
v_cvt_pk_bf16_f32 v84, v72, v73
v_cvt_pk_bf16_f32 v85, v74, v75
ds_write_b64 v9, v[84:85] offset:0
s_waitcnt lgkmcnt(0)
s_barrier
ds_read_b128 v[84:87], v10 offset:0
ds_read_b128 v[88:91], v10 offset:64
ds_read_b128 v[92:95], v10 offset:128
ds_read_b128 v[96:99], v10 offset:192
ds_read_b128 v[80:83], v52 offset:48
ds_read_b32 v56, v52 offset:36
s_waitcnt lgkmcnt(5)
v_mfma_f32_16x16x32_bf16 v[64:67], v[84:87], v[100:103], 0
s_waitcnt lgkmcnt(4)
v_mfma_f32_16x16x32_bf16 v[64:67], v[88:91], v[104:107], v[64:67]
s_waitcnt lgkmcnt(3)
v_mfma_f32_16x16x32_bf16 v[64:67], v[92:95], v[108:111], v[64:67]
s_waitcnt lgkmcnt(2)
v_mfma_f32_16x16x32_bf16 v[64:67], v[96:99], v[112:115], v[64:67]
s_waitcnt lgkmcnt(0)
v_mfma_f32_16x16x32_bf16 v[68:71], v[84:87], v[116:119], 0
v_mul_f32 v76, v76, v56
v_mfma_f32_16x16x32_bf16 v[68:71], v[88:91], v[120:123], v[68:71]
v_mul_f32 v77, v77, v56
v_mfma_f32_16x16x32_bf16 v[68:71], v[92:95], v[124:127], v[68:71]
v_mul_f32 v78, v78, v56
v_mfma_f32_16x16x32_bf16 v[68:71], v[96:99], v[192:195], v[68:71]
v_mul_f32 v79, v79, v56
v_mfma_f32_16x16x32_bf16 v[72:75], v[84:87], v[196:199], 0
v_fmac_f32_dpp v76, v64, v80 quad_perm:[0,1,2,3] row_mask:0x1 bank_mask:0xf
v_mfma_f32_16x16x32_bf16 v[72:75], v[88:91], v[200:203], v[72:75]
v_fmac_f32_dpp v76, v65, v81 quad_perm:[0,1,2,3] row_mask:0x1 bank_mask:0xf
v_mfma_f32_16x16x32_bf16 v[72:75], v[92:95], v[204:207], v[72:75]
v_fmac_f32_dpp v76, v66, v82 quad_perm:[0,1,2,3] row_mask:0x1 bank_mask:0xf
v_mfma_f32_16x16x32_bf16 v[72:75], v[96:99], v[208:211], v[72:75]
v_fmac_f32_dpp v76, v67, v83 quad_perm:[0,1,2,3] row_mask:0x1 bank_mask:0xf
v_mfma_f32_16x16x32_bf16 v[64:67], v[84:87], v[212:215], 0
v_fmac_f32_dpp v77, v68, v80 quad_perm:[0,1,2,3] row_mask:0x1 bank_mask:0xf
v_mfma_f32_16x16x32_bf16 v[64:67], v[88:91], v[216:219], v[64:67]
v_fmac_f32_dpp v77, v69, v81 quad_perm:[0,1,2,3] row_mask:0x1 bank_mask:0xf
v_mfma_f32_16x16x32_bf16 v[64:67], v[92:95], v[220:223], v[64:67]
v_fmac_f32_dpp v77, v70, v82 quad_perm:[0,1,2,3] row_mask:0x1 bank_mask:0xf
v_mfma_f32_16x16x32_bf16 v[64:67], v[96:99], v[224:227], v[64:67]
v_fmac_f32_dpp v77, v71, v83 quad_perm:[0,1,2,3] row_mask:0x1 bank_mask:0xf
v_mfma_f32_16x16x32_bf16 v[68:71], v[84:87], v[228:231], 0
v_fmac_f32_dpp v78, v72, v80 quad_perm:[0,1,2,3] row_mask:0x1 bank_mask:0xf
v_mfma_f32_16x16x32_bf16 v[68:71], v[88:91], v[232:235], v[68:71]
v_fmac_f32_dpp v78, v73, v81 quad_perm:[0,1,2,3] row_mask:0x1 bank_mask:0xf
v_mfma_f32_16x16x32_bf16 v[68:71], v[92:95], v[236:239], v[68:71]
v_fmac_f32_dpp v78, v74, v82 quad_perm:[0,1,2,3] row_mask:0x1 bank_mask:0xf
v_mfma_f32_16x16x32_bf16 v[68:71], v[96:99], v[240:243], v[68:71]
v_fmac_f32_dpp v78, v75, v83 quad_perm:[0,1,2,3] row_mask:0x1 bank_mask:0xf
v_mfma_f32_16x16x32_bf16 v[72:75], v[84:87], v[244:247], 0
v_fmac_f32_dpp v79, v64, v80 quad_perm:[0,1,2,3] row_mask:0x1 bank_mask:0xf
v_mfma_f32_16x16x32_bf16 v[72:75], v[88:91], v[248:251], v[72:75]
v_fmac_f32_dpp v79, v65, v81 quad_perm:[0,1,2,3] row_mask:0x1 bank_mask:0xf
v_mfma_f32_16x16x32_bf16 v[72:75], v[92:95], v[252:255], v[72:75]
v_fmac_f32_dpp v79, v66, v82 quad_perm:[0,1,2,3] row_mask:0x1 bank_mask:0xf
v_mfma_f32_16x16x32_bf16 v[72:75], v[96:99], v[128:131], v[72:75]
v_fmac_f32_dpp v79, v67, v83 quad_perm:[0,1,2,3] row_mask:0x1 bank_mask:0xf
v_mfma_f32_16x16x32_bf16 v[64:67], v[84:87], v[132:135], 0
v_fmac_f32_dpp v76, v68, v80 quad_perm:[0,1,2,3] row_mask:0x2 bank_mask:0xf
v_mfma_f32_16x16x32_bf16 v[64:67], v[88:91], v[136:139], v[64:67]
v_fmac_f32_dpp v76, v69, v81 quad_perm:[0,1,2,3] row_mask:0x2 bank_mask:0xf
v_mfma_f32_16x16x32_bf16 v[64:67], v[92:95], v[140:143], v[64:67]
v_fmac_f32_dpp v76, v70, v82 quad_perm:[0,1,2,3] row_mask:0x2 bank_mask:0xf
v_mfma_f32_16x16x32_bf16 v[64:67], v[96:99], v[144:147], v[64:67]
v_fmac_f32_dpp v76, v71, v83 quad_perm:[0,1,2,3] row_mask:0x2 bank_mask:0xf
v_mfma_f32_16x16x32_bf16 v[68:71], v[84:87], v[148:151], 0
v_fmac_f32_dpp v77, v72, v80 quad_perm:[0,1,2,3] row_mask:0x2 bank_mask:0xf
v_mfma_f32_16x16x32_bf16 v[68:71], v[88:91], v[152:155], v[68:71]
v_fmac_f32_dpp v77, v73, v81 quad_perm:[0,1,2,3] row_mask:0x2 bank_mask:0xf
v_mfma_f32_16x16x32_bf16 v[68:71], v[92:95], v[156:159], v[68:71]
v_fmac_f32_dpp v77, v74, v82 quad_perm:[0,1,2,3] row_mask:0x2 bank_mask:0xf
v_mfma_f32_16x16x32_bf16 v[68:71], v[96:99], v[160:163], v[68:71]
v_fmac_f32_dpp v77, v75, v83 quad_perm:[0,1,2,3] row_mask:0x2 bank_mask:0xf
v_fmac_f32_dpp v78, v64, v80 quad_perm:[0,1,2,3] row_mask:0x2 bank_mask:0xf
v_fmac_f32_dpp v78, v65, v81 quad_perm:[0,1,2,3] row_mask:0x2 bank_mask:0xf
v_fmac_f32_dpp v78, v66, v82 quad_perm:[0,1,2,3] row_mask:0x2 bank_mask:0xf
v_fmac_f32_dpp v78, v67, v83 quad_perm:[0,1,2,3] row_mask:0x2 bank_mask:0xf
v_bfi_b32 v84, s82, v24, v76
v_bfi_b32 v85, s82, v25, v77
v_bfi_b32 v86, s82, v26, v78
v_fmac_f32_dpp v79, v68, v80 quad_perm:[0,1,2,3] row_mask:0x2 bank_mask:0xf
v_fmac_f32_dpp v79, v69, v81 quad_perm:[0,1,2,3] row_mask:0x2 bank_mask:0xf
v_fmac_f32_dpp v79, v70, v82 quad_perm:[0,1,2,3] row_mask:0x2 bank_mask:0xf
v_fmac_f32_dpp v79, v71, v83 quad_perm:[0,1,2,3] row_mask:0x2 bank_mask:0xf
v_bfi_b32 v87, s82, v27, v79
buffer_store_dwordx4 v[84:87], v15, s[68:71], 0 offen sc1
s_cmp_lg_u32 s89, 0
s_cbranch_scc1 L_wend
s_mov_b32 s4, 0x10001
s_mov_b32 s5, s4
s_mov_b64 s[6:7], s[4:5]
s_mov_b64 s[8:9], s[4:5]
L_wpoll:
s_mov_b64 exec, s[4:5]
global_load_dwordx4 v[28:31], v54, s[30:31] sc1
s_mov_b64 exec, s[6:7]
global_load_dwordx4 v[32:35], v20, s[30:31] sc1
s_mov_b64 exec, -1
s_waitcnt vmcnt(0)
v_xor_b32 v192, v24, v28
v_xor_b32 v193, v25, v29
v_xor_b32 v194, v26, v30
v_xor_b32 v195, v27, v31
v_or3_b32 v36, v192, v193, v194
v_or_b32 v36, v36, v195
v_and_b32 v36, s82, v36
v_cmp_ne_u32 s[4:5], 0, v36
v_xor_b32 v196, v24, v32
v_xor_b32 v197, v25, v33
v_xor_b32 v198, v26, v34
v_xor_b32 v199, v27, v35
v_or3_b32 v36, v196, v197, v198
v_or_b32 v36, v36, v199
v_and_b32 v36, s82, v36
v_cmp_ne_u32 s[6:7], 0, v36
v_pk_add_f32 v[192:193], v[192:193], v[196:197]
v_pk_add_f32 v[194:195], v[194:195], v[198:199]
s_or_b64 s[20:21], s[4:5], s[6:7]
s_cbranch_scc0 L_wok
s_and_b64 s[20:21], s[20:21], s[8:9]
s_cselect_b64 s[8:9], s[8:9], -1
s_and_b64 s[4:5], s[4:5], s[8:9]
s_and_b64 s[6:7], s[6:7], s[8:9]
s_sub_u32 s90, s90, 1
s_cbranch_scc0 L_wpoll
L_wok:
s_mov_b64 exec, s[22:23]
buffer_store_dwordx2 v[22:23], off, s[24:27], 0
s_mov_b64 exec, -1
v_permlane32_swap_b32 v192, v194
v_permlane32_swap_b32 v193, v195
v_add_f32 v192, v192, v194
v_add_f32 v193, v193, v195
s_nop 1
v_permlane16_swap_b32 v192, v193
v_add_f32 v192, v192, v193
s_nop 1
v_add_f32_dpp v192, v192, v192 row_ror:1 row_mask:0xf bank_mask:0xf
s_nop 1
v_add_f32_dpp v192, v192, v192 row_ror:2 row_mask:0xf bank_mask:0xf
s_nop 1
v_add_f32_dpp v192, v192, v192 row_ror:4 row_mask:0xf bank_mask:0xf
s_nop 1
v_add_f32_dpp v192, v192, v192 row_ror:8 row_mask:0xf bank_mask:0xf
v_cvt_pk_bf16_f32 v192, v192, v192
buffer_store_short v192, v55, s[92:95], 0 offen
L_wend:
s_endpgm
L_codeend:
.section .rodata,"a"
.p2align 6
.amdhsa_kernel gated_mix__gqa_block_cached__sliding_block_cached__decode_kernel
  .amdhsa_next_free_vgpr 256
  .amdhsa_next_free_sgpr 100
  .amdhsa_accum_offset 256
  .amdhsa_group_segment_fixed_size 0
  .amdhsa_kernarg_size 112
  .amdhsa_user_sgpr_count 2
  .amdhsa_user_sgpr_kernarg_segment_ptr 1
  .amdhsa_system_sgpr_workgroup_id_x 1
  .amdhsa_float_denorm_mode_32 3
.end_amdhsa_kernel
```
